```python
import torch

def _softmax(x, axis=-1):
    return torch.softmax(x, dim=axis)
def _gelu(x):
    return torch.nn.functional.gelu(x, approximate="tanh")
def _silu(x):
    return torch.nn.functional.silu(x)
def _sigmoid(x):
    return torch.sigmoid(x)
def _layernorm(x, axis=-1, eps=1e-5):
    m = x.mean(dim=axis, keepdim=True)
    v = x.var(dim=axis, keepdim=True, unbiased=False)
    return (x - m) / torch.sqrt(v + eps)
def _scatter_add(tgt, idx, src, axis=0):
    return tgt.clone().index_add_(axis, idx, src)
def _segment_sum(src, seg, n):
    out = torch.zeros((n,) + src.shape[1:], dtype=src.dtype)
    return out.index_add_(0, seg, src)
def _pad(x, pw):
    flat = tuple(v for pair in reversed(pw) for v in pair)
    return torch.nn.functional.pad(x, flat)

kernel_name = 'standalone__edge_featured_mpnn_mpnn__graph'

def setup_inputs():

    _w = (lambda a: (lambda t: t.to(torch.bfloat16) if t.is_floating_point() else t)(torch.as_tensor(a)))
    N, deg, D, De = 50000, 16, 64, max(4, 1)
    E = N * deg
    H = 2 * D
    return {
        "x": _w((lambda *s: torch.randn(*s, dtype=torch.bfloat16) * 0.05)(N, D)),
        "e_attr": _w((lambda *s: torch.randn(*s, dtype=torch.bfloat16) * 1.6)(E, De)),
        "src": _w((lambda lo, hi, *s: torch.randint(lo, hi, s))(0, N, E).to(torch.int64)),
        "dst": _w((lambda lo, hi, *s: torch.randint(lo, hi, s))(0, N, E).to(torch.int64)),
        "w1": _w((lambda *s: torch.randn(*s, dtype=torch.bfloat16) * 1.6)(2 * D + De, H) * (1.0 / (2 * D + De) ** 0.5)),
        "b1": _w((lambda *s: torch.randn(*s, dtype=torch.bfloat16) * 3.2)(H) * 0.01),
        "w2": _w((lambda *s: torch.randn(*s, dtype=torch.bfloat16) * 0.05)(H, D) * (1.0 / H ** 0.5)),
        "b2": _w((lambda *s: torch.randn(*s, dtype=torch.bfloat16) * 0.1)(D) * 0.01),
    }

def reference(x, e_attr, src, dst, w1, b1, w2, b2):
    N, D = x.shape
    h_src = x[src]
    h_dst = x[dst]
    m_in = torch.concatenate([h_src, h_dst, e_attr], axis=-1)
    h = _silu(m_in @ w1 + b1)
    msg = h @ w2 + b2
    return _segment_sum(msg, dst, N)
```

```asm
; @launch grid=(256,1,1) block=(256,1,1) lds=163600
.amdgcn_target "amdgcn-amd-amdhsa--gfx950"
.text
.p2align 12
.globl standalone__edge_featured_mpnn_mpnn__graph_kernel
.p2align 8
.type standalone__edge_featured_mpnn_mpnn__graph_kernel,@function
standalone__edge_featured_mpnn_mpnn__graph_kernel:
    s_cmp_ge_u32 s2, 256
    s_cbranch_scc1 K_END0
    s_load_dwordx16 s[64:79], s[0:1], 0
    s_load_dwordx4 s[80:83], s[0:1], 64
    s_load_dwordx2 s[12:13], s[0:1], 80
    s_getpc_b64 s[62:63]
K_PC:
    s_bfe_u32 s3, s2, 0x30003
    v_and_b32 v2, 0xf8, v0
    v_add_lshl_u32 v41, v2, s3, 7
    v_min_u32 v2, K_SLOW0-K_PC, v41
    v_mov_b32 v3, 0
    v_lshl_add_u64 v[2:3], v[2:3], 0, s[62:63]
    global_load_dword v10, v[2:3], off
    v_lshrrev_b32 v2, 6, v0
    v_and_b32 v6, 63, v0
    v_lshlrev_b32 v17, 2, v0
    v_readfirstlane_b32 s18, v2
    v_mov_b32 v24, 0
    ds_write_b32 v17, v24 offset:38912
    v_lshlrev_b32 v16, 4, v0
    v_lshlrev_b32 v4, 4, v6
    s_and_b32 s84, s2, 7
    s_lshl_b32 s84, s84, 5
    s_lshr_b32 s3, s2, 3
    s_add_u32 s84, s84, s3
    s_mov_b32 s15, 0x20000
    s_mov_b32 s14, 268435456
    s_mov_b32 s30, 3200000
    s_mov_b32 s34, s30
    s_mov_b32 s31, s15
    s_mov_b32 s35, s15
    s_mov_b32 s43, s15
    s_mov_b32 s47, s15
    s_mov_b32 s51, s15
    s_mov_b32 s55, s15
    s_mov_b32 s7, s15
    s_mov_b32 s11, s15
    s_mov_b32 s42, 33792
    s_movk_i32 s46, 16384
    s_mov_b32 s54, 6400000
    s_mov_b32 s26, 6400000
    s_mov_b32 s6, s26
    s_mov_b32 s10, s26
    s_lshr_b32 s19, s84, 5
    s_mul_i32 s19, s19, 400000
    s_and_b32 s20, s84, 31
    s_mul_i32 s21, s20, 212
    s_add_u32 s21, s21, s19
    s_add_u32 s21, s21, 392448
    s_lshl_b32 s20, s20, 12
    s_add_u32 s60, s19, s20
    s_add_u32 s19, s60, 0x20000
    s_add_u32 s20, s60, 0x40000
    v_mov_b32 v20, -1
    v_mov_b32 v21, -1
    v_mov_b32 v22, -1
    v_mov_b32 v23, -1
    s_movk_i32 s58, 256
    s_mov_b32 s59, s15
    s_and_b32 s37, s84, 3
    s_lshl_b32 s61, s18, 0
    s_add_u32 s61, s61, s84
    s_lshl_b32 s36, s61, 4
    s_add_u32 s36, s36, 262144
    s_lshl_b32 s61, s61, 10
    v_mov_b32 v29, 1
    v_lshlrev_b32 v18, 5, v0
    v_lshlrev_b32 v19, 3, v0
    v_lshlrev_b32 v43, 2, v6
    s_mul_i32 s16, s84, 12800051
    s_add_u32 s16, s16, 0xffff
    s_add_u32 s17, s16, 12800051
    s_lshr_b32 s16, s16, 16
    s_lshr_b32 s17, s17, 16
    s_min_u32 s17, s17, 50000
    s_sub_u32 s17, s17, s16
    s_mov_b32 s85, 85899
    v_subrev_u32 v45, 192, v0
    v_cmp_gt_u32 vcc, 53, v45
    v_mov_b32 v45, 0x1000000
    s_mov_b32 s39, 0x05040100
    v_cndmask_b32 v45, v45, v24, vcc
    v_lshrrev_b32 v42, 2, v6
    v_lshlrev_b32 v42, 14, v42
    v_and_b32 v37, 63, v4
    v_add_u32 v42, v42, v37
    v_lshrrev_b32 v1, 5, v6
    v_bfe_u32 v52, v6, 2, 2
    v_and_b32 v53, 3, v6
    v_bfe_u32 v54, v6, 4, 1
    v_lshlrev_b32 v55, 3, v53
    v_lshl_add_u32 v55, v54, 5, v55
    v_lshl_add_u32 v56, v52, 8, v55
    v_lshl_add_u32 v60, v1, 10, v56
    v_add_u32 v60, 79104, v60
    v_lshl_add_u32 v56, v1, 13, v56
    v_lshl_add_u32 v56, v52, 6, v56
    v_add_u32 v56, 46336, v56
    v_xor_b32 v57, 64, v56
    v_xor_b32 v58, 0x80, v56
    v_xor_b32 v59, 0xc0, v56
    v_and_b32 v55, 1, v53
    v_lshlrev_b32 v55, 6, v55
    v_lshl_add_u32 v55, v54, 4, v55
    v_lshrrev_b32 v53, 1, v53
    v_lshl_add_u32 v55, v53, 3, v55
    v_lshl_add_u32 v62, v52, 7, v55
    v_lshl_add_u32 v62, v1, 9, v62
    v_add_u32 v62, 83200, v62
    v_and_b32 v52, 1, v52
    v_lshl_add_u32 v63, v52, 5, v55
    v_lshl_add_u32 v63, v1, 8, v63
    v_add_u32 v63, 81152, v63
    v_lshlrev_b32 v1, 6, v1
    s_waitcnt lgkmcnt(0)
    s_mov_b64 s[28:29], s[70:71]
    buffer_load_dwordx4 v[64:67], v16, s[28:31], s60 offen
    buffer_load_dwordx4 v[68:71], v16, s[28:31], s19 offen
    buffer_load_dwordx4 v[72:75], v16, s[28:31], s20 offen
    buffer_load_dword v76, v17, s[28:31], s21 offen
    s_mov_b64 s[32:33], s[68:69]
    s_cmp_lg_u32 s37, 0
    s_cbranch_scc1 R_NOT1
    buffer_store_dwordx4 v[20:23], v4, s[12:15], s61 offen offset:0 sc1
    s_mov_b64 exec, 0x1
    buffer_store_dwordx4 v[20:23], v4, s[12:15], s36 offen sc1
    s_mov_b64 exec, -1
R_NOT1:
    buffer_load_dwordx4 v[80:83], v16, s[32:35], s60 offen
    buffer_load_dwordx4 v[84:87], v16, s[32:35], s19 offen
    buffer_load_dwordx4 v[88:91], v16, s[32:35], s20 offen
    buffer_load_dword v92, v17, s[32:35], s21 offen
    s_barrier
    s_mov_b64 s[40:41], s[72:73]
    s_mov_b64 s[44:45], s[76:77]
    s_cmp_eq_u32 s18, 0
    s_cselect_b64 s[48:49], s[74:75], s[78:79]
    s_cselect_b32 s50, 0x100, 0
    s_cmp_eq_u32 s18, 2
    s_cselect_b32 s50, 0x80, s50
    s_mov_b32 s3, 0x8000
    buffer_load_dword v10, v41, s[40:43], 0 offen
    buffer_load_dword v10, v41, s[44:47], 0 offen
    buffer_load_dword v240, v17, s[40:43], s3 offen
    buffer_load_dword v241, v43, s[48:51], 0 offen
    s_mov_b64 s[52:53], s[66:67]
    s_lshl_b32 s60, s60, 1
    s_lshl_b32 s19, s19, 1
    s_lshl_b32 s20, s20, 1
    s_lshl_b32 s21, s21, 1
    v_mov_b32 v25, 0
    v_mov_b32 v26, 0
    v_mov_b32 v27, 0
    v_add_u32 v5, 125184, v16
    ds_write_b128 v5, v[24:27] offset:0
    ds_write_b128 v5, v[24:27] offset:4096
    ds_write_b128 v5, v[24:27] offset:8192
    ds_write_b128 v5, v[24:27] offset:12288
    ds_write_b128 v5, v[24:27] offset:16384
    ds_write_b128 v5, v[24:27] offset:20480
    ds_write_b128 v5, v[24:27] offset:24576
    buffer_load_dwordx4 v[96:99], v18, s[52:55], s60 offen
    ds_write_b128 v5, v[24:27] offset:28672
    buffer_load_dwordx4 v[100:103], v18, s[52:55], s60 offen offset:16
    ds_write_b128 v5, v[24:27] offset:32768
    buffer_load_dwordx4 v[104:107], v18, s[52:55], s19 offen
    ds_write_b128 v5, v[24:27] offset:36864
    buffer_load_dwordx4 v[108:111], v18, s[52:55], s19 offen offset:16
    v_mov_b32 v28, 0x7a0000ff
    v_cmp_eq_u32 vcc, 2, v2
    ds_write_b32 v17, v28 offset:44288
    v_mov_b32 v28, 0x1000000
    v_cndmask_b32 v3, v24, v28, vcc
    ds_write_b32 v17, v3 offset:43264
    ds_write_b32 v17, v28 offset:45312
    v_and_b32 v3, 0x7c, v43
    ds_write_b32 v3, v20 offset:12500
    s_mov_b64 s[4:5], s[64:65]
    s_mov_b64 s[8:9], s[80:81]
    s_mul_i32 s3, s84, 12800
    s_add_u32 s3, s3, 294912
    s_add_u32 s28, s12, s3
    s_addc_u32 s29, s13, 0
    s_movk_i32 s30, 12672
    s_mul_i32 s3, s84, 25600
    s_add_u32 s3, s3, 3571712
    s_add_u32 s32, s12, s3
    s_addc_u32 s33, s13, 0
    s_movk_i32 s34, 25216
    s_lshl_b32 s38, s18, 12
    s_mov_b64 s[56:57], s[82:83]
    s_cmp_lg_u32 s37, 0
    s_waitcnt vmcnt(14)
    s_cbranch_scc0 R_W0
    s_waitcnt vmcnt(12)
R_W0:
    v_mul_u32_u24 v128, s85, v64
    v_lshlrev_b32_sdwa v128, 2, v128 dst_sel:DWORD dst_unused:UNUSED_PAD src0_sel:DWORD src1_sel:BYTE_3
    ds_add_rtn_u32 v144, v128, v29 offset:38912
    v_mul_u32_u24 v129, s85, v65
    v_lshlrev_b32_sdwa v129, 2, v129 dst_sel:DWORD dst_unused:UNUSED_PAD src0_sel:DWORD src1_sel:BYTE_3
    ds_add_rtn_u32 v145, v129, v29 offset:38912
    v_mul_u32_u24 v130, s85, v66
    v_lshlrev_b32_sdwa v130, 2, v130 dst_sel:DWORD dst_unused:UNUSED_PAD src0_sel:DWORD src1_sel:BYTE_3
    ds_add_rtn_u32 v146, v130, v29 offset:38912
    v_mul_u32_u24 v131, s85, v67
    v_lshlrev_b32_sdwa v131, 2, v131 dst_sel:DWORD dst_unused:UNUSED_PAD src0_sel:DWORD src1_sel:BYTE_3
    ds_add_rtn_u32 v147, v131, v29 offset:38912
    v_mul_u32_u24 v132, s85, v68
    v_lshlrev_b32_sdwa v132, 2, v132 dst_sel:DWORD dst_unused:UNUSED_PAD src0_sel:DWORD src1_sel:BYTE_3
    ds_add_rtn_u32 v148, v132, v29 offset:38912
    v_mul_u32_u24 v133, s85, v69
    v_lshlrev_b32_sdwa v133, 2, v133 dst_sel:DWORD dst_unused:UNUSED_PAD src0_sel:DWORD src1_sel:BYTE_3
    ds_add_rtn_u32 v149, v133, v29 offset:38912
    v_mul_u32_u24 v134, s85, v70
    v_lshlrev_b32_sdwa v134, 2, v134 dst_sel:DWORD dst_unused:UNUSED_PAD src0_sel:DWORD src1_sel:BYTE_3
    ds_add_rtn_u32 v150, v134, v29 offset:38912
    v_mul_u32_u24 v135, s85, v71
    v_lshlrev_b32_sdwa v135, 2, v135 dst_sel:DWORD dst_unused:UNUSED_PAD src0_sel:DWORD src1_sel:BYTE_3
    ds_add_rtn_u32 v151, v135, v29 offset:38912
    v_mul_u32_u24 v136, s85, v72
    v_lshlrev_b32_sdwa v136, 2, v136 dst_sel:DWORD dst_unused:UNUSED_PAD src0_sel:DWORD src1_sel:BYTE_3
    ds_add_rtn_u32 v152, v136, v29 offset:38912
    v_mul_u32_u24 v137, s85, v73
    v_lshlrev_b32_sdwa v137, 2, v137 dst_sel:DWORD dst_unused:UNUSED_PAD src0_sel:DWORD src1_sel:BYTE_3
    ds_add_rtn_u32 v153, v137, v29 offset:38912
    v_mul_u32_u24 v138, s85, v74
    v_lshlrev_b32_sdwa v138, 2, v138 dst_sel:DWORD dst_unused:UNUSED_PAD src0_sel:DWORD src1_sel:BYTE_3
    ds_add_rtn_u32 v154, v138, v29 offset:38912
    v_mul_u32_u24 v139, s85, v75
    v_lshlrev_b32_sdwa v139, 2, v139 dst_sel:DWORD dst_unused:UNUSED_PAD src0_sel:DWORD src1_sel:BYTE_3
    ds_add_rtn_u32 v155, v139, v29 offset:38912
    v_mul_u32_u24 v140, s85, v76
    v_lshlrev_b32_sdwa v140, 2, v140 dst_sel:DWORD dst_unused:UNUSED_PAD src0_sel:DWORD src1_sel:BYTE_3
    v_or_b32 v140, v45, v140
    ds_add_rtn_u32 v156, v140, v29 offset:38912
    v_lshrrev_b32 v11, 3, v0
    v_min_u32 v11, 24, v11
    v_lshlrev_b32 v11, 10, v11
    s_lshl_b32 s3, s16, 7
    buffer_load_dword v10, v11, s[4:7], s3 offen
    s_lshl2_add_u32 s37, s37, s18
    s_cmp_eq_u32 s18, 0
    s_waitcnt lgkmcnt(0)
    s_barrier
    s_cbranch_scc1 K_SCAN
    s_cmp_eq_u32 s18, 1
    s_cbranch_scc1 PG1
    s_cmp_eq_u32 s18, 2
    s_cbranch_scc1 PG2
    s_branch PG3
K_SCAN:
    ds_read_b128 v[32:35], v4 offset:38912
    s_waitcnt lgkmcnt(0)
    v_add_u32 v38, v32, v33
    v_add_u32 v39, v38, v34
    v_add_u32 v41, v39, v35
    v_mov_b32 v36, v41
    s_nop 1
    v_add_u32_dpp v36, v36, v36 row_shr:1 row_mask:0xf bank_mask:0xf bound_ctrl:0
    s_nop 1
    v_add_u32_dpp v36, v36, v36 row_shr:2 row_mask:0xf bank_mask:0xf bound_ctrl:0
    s_nop 1
    v_add_u32_dpp v36, v36, v36 row_shr:4 row_mask:0xf bank_mask:0xf bound_ctrl:0
    s_nop 1
    v_add_u32_dpp v36, v36, v36 row_shr:8 row_mask:0xf bank_mask:0xf bound_ctrl:0
    s_nop 1
    v_add_u32_dpp v36, v36, v36 row_bcast:15 row_mask:0xa bank_mask:0xf
    s_nop 1
    v_add_u32_dpp v36, v36, v36 row_bcast:31 row_mask:0xc bank_mask:0xf
    v_sub_u32 v36, v36, v41
    v_add_u32 v37, v36, v32
    v_add_u32 v38, v36, v38
    v_add_u32 v39, v36, v39
    ds_write_b128 v4, v[36:39] offset:39936
    v_lshl_or_b32 v32, v32, 16, v36
    v_lshl_or_b32 v33, v33, 16, v37
    v_lshl_or_b32 v34, v34, 16, v38
    v_lshl_or_b32 v35, v35, 16, v39
    s_waitcnt lgkmcnt(0)
K_WARM_RET:
    s_barrier
    ds_read_b32 v128, v128 offset:39936
    ds_read_b32 v129, v129 offset:39936
    ds_read_b32 v130, v130 offset:39936
    ds_read_b32 v131, v131 offset:39936
    ds_read_b32 v132, v132 offset:39936
    ds_read_b32 v133, v133 offset:39936
    ds_read_b32 v134, v134 offset:39936
    ds_read_b32 v135, v135 offset:39936
    ds_read_b32 v136, v136 offset:39936
    ds_read_b32 v137, v137 offset:39936
    ds_read_b32 v138, v138 offset:39936
    ds_read_b32 v139, v139 offset:39936
    ds_read_b32 v140, v140 offset:39936
    s_waitcnt vmcnt(9)
    v_perm_b32 v64, v80, v64, s39
    v_perm_b32 v65, v81, v65, s39
    v_perm_b32 v66, v82, v66, s39
    v_perm_b32 v67, v83, v67, s39
    v_perm_b32 v68, v84, v68, s39
    v_perm_b32 v69, v85, v69, s39
    v_perm_b32 v70, v86, v70, s39
    v_perm_b32 v71, v87, v71, s39
    v_perm_b32 v72, v88, v72, s39
    v_perm_b32 v73, v89, v73, s39
    v_perm_b32 v74, v90, v74, s39
    v_perm_b32 v75, v91, v75, s39
    v_perm_b32 v76, v92, v76, s39
    s_waitcnt lgkmcnt(7)
    v_add_lshl_u32 v128, v128, v144, 2
    ds_write_b32 v128, v64 offset:0
    v_add_lshl_u32 v129, v129, v145, 2
    ds_write_b32 v129, v65 offset:0
    v_add_lshl_u32 v130, v130, v146, 2
    ds_write_b32 v130, v66 offset:0
    v_add_lshl_u32 v131, v131, v147, 2
    ds_write_b32 v131, v67 offset:0
    v_add_lshl_u32 v132, v132, v148, 2
    ds_write_b32 v132, v68 offset:0
    v_add_lshl_u32 v133, v133, v149, 2
    ds_write_b32 v133, v69 offset:0
    s_waitcnt lgkmcnt(6)
    v_add_lshl_u32 v134, v134, v150, 2
    ds_write_b32 v134, v70 offset:0
    v_add_lshl_u32 v135, v135, v151, 2
    ds_write_b32 v135, v71 offset:0
    v_add_lshl_u32 v136, v136, v152, 2
    ds_write_b32 v136, v72 offset:0
    v_add_lshl_u32 v137, v137, v153, 2
    ds_write_b32 v137, v73 offset:0
    v_add_lshl_u32 v138, v138, v154, 2
    ds_write_b32 v138, v74 offset:0
    v_add_lshl_u32 v139, v139, v155, 2
    ds_write_b32 v139, v75 offset:0
    v_add_lshl_u32 v140, v140, v156, 2
    v_or_b32 v140, v45, v140
    ds_write_b32 v140, v76 offset:0
    s_waitcnt lgkmcnt(0)
    s_barrier
    s_cmp_lg_u32 s37, 3
    s_cbranch_scc1 K_NOH
    s_lshr_b32 s3, s84, 2
    s_and_b32 s3, s3, 3
    s_lshl_b32 s3, s3, 6
    s_mov_b64 exec, 1
    buffer_atomic_add v29, v24, s[56:59], s3 offen
    s_mov_b64 exec, -1
K_NOH:
    ds_read_b128 v[176:179], v16 offset:0
    ds_read_b128 v[180:183], v16 offset:4096
    ds_read_b128 v[184:187], v16 offset:8192
    ds_read_b128 v[188:191], v16 offset:12288
    v_lshlrev_b32 v160, 1, v128
    v_lshlrev_b32 v161, 1, v129
    v_lshlrev_b32 v162, 1, v130
    v_lshlrev_b32 v163, 1, v131
    v_lshlrev_b32 v164, 1, v132
    v_lshlrev_b32 v165, 1, v133
    v_lshlrev_b32 v166, 1, v134
    v_lshlrev_b32 v167, 1, v135
    v_lshlrev_b32 v168, 1, v136
    v_lshlrev_b32 v169, 1, v137
    v_lshlrev_b32 v170, 1, v138
    v_lshlrev_b32 v171, 1, v139
    v_lshlrev_b32 v172, 1, v140
    s_movk_i32 s3, 0
    s_waitcnt lgkmcnt(3)
    buffer_store_dwordx4 v[176:179], v16, s[28:31], s3 offen sc1
    s_movk_i32 s3, 4096
    s_waitcnt lgkmcnt(2)
    buffer_store_dwordx4 v[180:183], v16, s[28:31], s3 offen sc1
    s_movk_i32 s3, 8192
    s_waitcnt lgkmcnt(1)
    buffer_store_dwordx4 v[184:187], v16, s[28:31], s3 offen sc1
    s_movk_i32 s3, 12288
    s_waitcnt lgkmcnt(0)
    buffer_store_dwordx4 v[188:191], v16, s[28:31], s3 offen sc1
    buffer_load_dwordx4 v[112:115], v18, s[52:55], s20 offen
    buffer_load_dwordx4 v[116:119], v18, s[52:55], s20 offen offset:16
    buffer_load_dwordx2 v[120:121], v19, s[52:55], s21 offen
    s_lshr_b32 s36, s84, 4
    s_lshl_b32 s36, s36, 14
    s_and_b32 s3, s84, 15
    s_lshl2_add_u32 s36, s3, s36
    v_lshlrev_b32 v3, 6, v0
    s_lshl_b32 s60, s84, 6
    s_lshl_b32 s61, s84, 4
    v_lshlrev_b32 v41, 4, v0
    s_add_u32 s61, s61, 262144
    s_mov_b32 s24, 0xbfb8aa3b
    s_mov_b32 s25, 0xbfb8aa3b
    s_mov_b32 s27, 0xffff0000
    v_and_b32 v5, 0x300, v16
    v_lshrrev_b32 v5, 2, v5
    v_xor_b32 v5, v5, v16
    v_add_u32 v5, 46336, v5
    v_lshl_add_u32 v7, v2, 8, v17
    v_add_u32 v7, 80128, v7
    v_add_u32 v9, 79104, v17
    s_lshl_b32 s23, s18, 11
    v_and_b32 v48, 0x380, v4
    v_bfe_u32 v49, v6, 2, 1
    v_lshl_add_u32 v48, v49, 10, v48
    v_and_b32 v30, 48, v4
    v_lshl_add_u32 v48, v30, 1, v48
    v_add_u32 v48, s23, v48
    v_add_u32 v49, 8, v48
    v_add_u32 v50, 16, v48
    v_add_u32 v51, 24, v48
    s_mul_i32 s22, s16, 196
    s_sub_u32 s22, 125184, s22
    v_mov_b32 v28, 196
    v_and_or_b32 v31, v4, 16, 2.0
    v_mul_u32_u24 v44, 3200, v0
    v_and_b32 v26, 0x70, v4
    v_add_u32 v27, 0x80000000, v30
    v_lshrrev_b32 v46, 3, v0
    v_lshlrev_b32 v47, 4, v46
    v_xor_b32 v47, v47, v4
    v_and_b32 v47, 0x70, v47
    v_add_u32 v46, s16, v46
    v_lshl_add_u32 v55, v46, 7, v47
    s_lshl_b32 s62, s18, 10
    s_add_u32 s62, s62, 99584
    s_cmp_eq_u32 s18, 0
    s_mov_b32 s63, 0x3f000
    s_cselect_b32 s63, 124160, s63
    v_and_b32 v22, 0xcf, v0
    v_cmp_eq_u32 vcc, 0x80, v22
    s_cmp_eq_u32 s18, 2
    s_cselect_b32 s37, 0, 0x1000
    v_cndmask_b32_e64 v22, 0, 16, vcc
    s_waitcnt vmcnt(10)
    ds_write_b64 v160, v[96:97] offset:12800
    ds_write_b64 v161, v[98:99] offset:12800
    s_movk_i32 s3, 0
    buffer_load_dwordx4 v[208:211], v16, s[40:43], s3 offen
    ds_write_b64 v162, v[100:101] offset:12800
    s_movk_i32 s3, 4096
    buffer_load_dwordx4 v[212:215], v16, s[40:43], s3 offen
    ds_write_b64 v163, v[102:103] offset:12800
    s_movk_i32 s3, 8192
    buffer_load_dwordx4 v[216:219], v16, s[40:43], s3 offen
    s_waitcnt vmcnt(11)
    ds_write_b64 v164, v[104:105] offset:12800
    s_movk_i32 s3, 12288
    buffer_load_dwordx4 v[220:223], v16, s[40:43], s3 offen
    ds_write_b64 v165, v[106:107] offset:12800
    s_movk_i32 s3, 16384
    buffer_load_dwordx4 v[224:227], v16, s[40:43], s3 offen
    ds_write_b64 v166, v[108:109] offset:12800
    s_movk_i32 s3, 20480
    buffer_load_dwordx4 v[228:231], v16, s[40:43], s3 offen
    ds_write_b64 v167, v[110:111] offset:12800
    s_movk_i32 s3, 24576
    buffer_load_dwordx4 v[232:235], v16, s[40:43], s3 offen
    s_waitcnt vmcnt(7)
    ds_write_b64 v168, v[112:113] offset:12800
    s_movk_i32 s3, 28672
    buffer_load_dwordx4 v[236:239], v16, s[40:43], s3 offen
    ds_write_b64 v169, v[114:115] offset:12800
    buffer_load_dwordx4 v[148:151], v4, s[44:47], s38 offen offset:0
    ds_write_b64 v170, v[116:117] offset:12800
    buffer_load_dwordx4 v[152:155], v4, s[44:47], s38 offen offset:1024
    ds_write_b64 v171, v[118:119] offset:12800
    buffer_load_dwordx4 v[156:159], v4, s[44:47], s38 offen offset:2048
    buffer_load_dword v20, v43, s[56:59], s37 offen sc1
    ds_write_b64 v172, v[120:121] offset:12800
    buffer_load_dwordx4 v[248:251], v4, s[44:47], s38 offen offset:3072
    s_waitcnt vmcnt(1)
    v_cmp_lt_u32 vcc, v20, v22
    s_cbranch_vccnz K_H
K_H_RET:
    s_cmp_lg_u32 s18, 0
    s_waitcnt lgkmcnt(0)
    s_barrier
    s_cbranch_scc1 K_NOTAB
    buffer_store_dwordx4 v[32:35], v42, s[12:15], s60 offen sc1
K_NOTAB:
    ds_read_b128 v[176:179], v16 offset:12800
    ds_read_b128 v[180:183], v16 offset:16896
    ds_read_b128 v[184:187], v16 offset:20992
    ds_read_b128 v[188:191], v16 offset:25088
    ds_read_b128 v[192:195], v16 offset:29184
    ds_read_b128 v[196:199], v16 offset:33280
    ds_read_b128 v[200:203], v16 offset:37376
    s_branch PG1E
K_H:
    s_mov_b32 s3, 400000
K_H_L:
    s_mov_b64 exec, vcc
    s_sleep 4
    buffer_load_dword v20, v43, s[56:59], s37 offen sc1
    s_sub_u32 s3, s3, 1
    s_cbranch_scc1 K_END
    s_waitcnt vmcnt(0)
    v_cmp_lt_u32 vcc, v20, v22
    s_cbranch_vccnz K_H_L
    s_mov_b64 exec, -1
    s_branch K_H_RET
.p2align 12
PG1:
    s_branch K_WARM_RET
    s_nop 0
PG1E:
    s_movk_i32 s3, 0
    s_waitcnt lgkmcnt(6)
    buffer_store_dwordx4 v[176:179], v16, s[32:35], s3 offen sc1
    s_movk_i32 s3, 4096
    s_waitcnt lgkmcnt(5)
    buffer_store_dwordx4 v[180:183], v16, s[32:35], s3 offen sc1
    s_movk_i32 s3, 8192
    s_waitcnt lgkmcnt(4)
    buffer_store_dwordx4 v[184:187], v16, s[32:35], s3 offen sc1
    s_movk_i32 s3, 12288
    s_waitcnt lgkmcnt(3)
    buffer_store_dwordx4 v[188:191], v16, s[32:35], s3 offen sc1
    s_movk_i32 s3, 16384
    s_waitcnt lgkmcnt(2)
    buffer_store_dwordx4 v[192:195], v16, s[32:35], s3 offen sc1
    s_movk_i32 s3, 20480
    s_waitcnt lgkmcnt(1)
    buffer_store_dwordx4 v[196:199], v16, s[32:35], s3 offen sc1
    s_movk_i32 s3, 24576
    s_waitcnt lgkmcnt(0)
    buffer_store_dwordx4 v[200:203], v16, s[32:35], s3 offen sc1
    s_cmp_lg_u32 s18, 0
    s_waitcnt vmcnt(8)
    s_cbranch_scc0 K_WW
    s_waitcnt vmcnt(7)
K_WW:
.p2align 3
    v_lshlrev_b32 v64, 16, v208
    v_and_b32 v65, s27, v208
    v_pk_mul_f32 v[64:65], v[64:65], s[24:25]
    v_cvt_pk_bf16_f32 v208, v64, v65
    v_lshlrev_b32 v66, 16, v209
    v_and_b32 v67, s27, v209
    v_pk_mul_f32 v[66:67], v[66:67], s[24:25]
    v_cvt_pk_bf16_f32 v209, v66, v67
    v_lshlrev_b32 v68, 16, v210
    v_and_b32 v69, s27, v210
    v_pk_mul_f32 v[68:69], v[68:69], s[24:25]
    v_cvt_pk_bf16_f32 v210, v68, v69
    v_lshlrev_b32 v70, 16, v211
    v_and_b32 v71, s27, v211
    v_pk_mul_f32 v[70:71], v[70:71], s[24:25]
    v_cvt_pk_bf16_f32 v211, v70, v71
    ds_write_b128 v5, v[208:211] offset:0
    v_lshlrev_b32 v64, 16, v212
    v_and_b32 v65, s27, v212
    v_pk_mul_f32 v[64:65], v[64:65], s[24:25]
    v_cvt_pk_bf16_f32 v212, v64, v65
    v_lshlrev_b32 v66, 16, v213
    v_and_b32 v67, s27, v213
    v_pk_mul_f32 v[66:67], v[66:67], s[24:25]
    v_cvt_pk_bf16_f32 v213, v66, v67
    v_lshlrev_b32 v68, 16, v214
    v_and_b32 v69, s27, v214
    v_pk_mul_f32 v[68:69], v[68:69], s[24:25]
    v_cvt_pk_bf16_f32 v214, v68, v69
    v_lshlrev_b32 v70, 16, v215
    v_and_b32 v71, s27, v215
    v_pk_mul_f32 v[70:71], v[70:71], s[24:25]
    v_cvt_pk_bf16_f32 v215, v70, v71
    ds_write_b128 v5, v[212:215] offset:4096
    v_lshlrev_b32 v64, 16, v216
    v_and_b32 v65, s27, v216
    v_pk_mul_f32 v[64:65], v[64:65], s[24:25]
    v_cvt_pk_bf16_f32 v216, v64, v65
    v_lshlrev_b32 v66, 16, v217
    v_and_b32 v67, s27, v217
    v_pk_mul_f32 v[66:67], v[66:67], s[24:25]
    v_cvt_pk_bf16_f32 v217, v66, v67
    v_lshlrev_b32 v68, 16, v218
    v_and_b32 v69, s27, v218
    v_pk_mul_f32 v[68:69], v[68:69], s[24:25]
    v_cvt_pk_bf16_f32 v218, v68, v69
    v_lshlrev_b32 v70, 16, v219
    v_and_b32 v71, s27, v219
    v_pk_mul_f32 v[70:71], v[70:71], s[24:25]
    v_cvt_pk_bf16_f32 v219, v70, v71
    ds_write_b128 v5, v[216:219] offset:8192
    v_lshlrev_b32 v64, 16, v220
    v_and_b32 v65, s27, v220
    v_pk_mul_f32 v[64:65], v[64:65], s[24:25]
    v_cvt_pk_bf16_f32 v220, v64, v65
    v_lshlrev_b32 v66, 16, v221
    v_and_b32 v67, s27, v221
    v_pk_mul_f32 v[66:67], v[66:67], s[24:25]
    v_cvt_pk_bf16_f32 v221, v66, v67
    v_lshlrev_b32 v68, 16, v222
    v_and_b32 v69, s27, v222
    v_pk_mul_f32 v[68:69], v[68:69], s[24:25]
    v_cvt_pk_bf16_f32 v222, v68, v69
    v_lshlrev_b32 v70, 16, v223
    v_and_b32 v71, s27, v223
    v_pk_mul_f32 v[70:71], v[70:71], s[24:25]
    v_cvt_pk_bf16_f32 v223, v70, v71
    ds_write_b128 v5, v[220:223] offset:12288
    v_lshlrev_b32 v64, 16, v224
    v_and_b32 v65, s27, v224
    v_pk_mul_f32 v[64:65], v[64:65], s[24:25]
    v_cvt_pk_bf16_f32 v224, v64, v65
    v_lshlrev_b32 v66, 16, v225
    v_and_b32 v67, s27, v225
    v_pk_mul_f32 v[66:67], v[66:67], s[24:25]
    v_cvt_pk_bf16_f32 v225, v66, v67
    v_lshlrev_b32 v68, 16, v226
    v_and_b32 v69, s27, v226
    v_pk_mul_f32 v[68:69], v[68:69], s[24:25]
    v_cvt_pk_bf16_f32 v226, v68, v69
    v_lshlrev_b32 v70, 16, v227
    v_and_b32 v71, s27, v227
    v_pk_mul_f32 v[70:71], v[70:71], s[24:25]
    v_cvt_pk_bf16_f32 v227, v70, v71
    ds_write_b128 v5, v[224:227] offset:16384
    v_lshlrev_b32 v64, 16, v228
    v_and_b32 v65, s27, v228
    v_pk_mul_f32 v[64:65], v[64:65], s[24:25]
    v_cvt_pk_bf16_f32 v228, v64, v65
    v_lshlrev_b32 v66, 16, v229
    v_and_b32 v67, s27, v229
    v_pk_mul_f32 v[66:67], v[66:67], s[24:25]
    v_cvt_pk_bf16_f32 v229, v66, v67
    v_lshlrev_b32 v68, 16, v230
    v_and_b32 v69, s27, v230
    v_pk_mul_f32 v[68:69], v[68:69], s[24:25]
    v_cvt_pk_bf16_f32 v230, v68, v69
    v_lshlrev_b32 v70, 16, v231
    v_and_b32 v71, s27, v231
    v_pk_mul_f32 v[70:71], v[70:71], s[24:25]
    v_cvt_pk_bf16_f32 v231, v70, v71
    ds_write_b128 v5, v[228:231] offset:20480
    v_lshlrev_b32 v64, 16, v232
    v_and_b32 v65, s27, v232
    v_pk_mul_f32 v[64:65], v[64:65], s[24:25]
    v_cvt_pk_bf16_f32 v232, v64, v65
    v_lshlrev_b32 v66, 16, v233
    v_and_b32 v67, s27, v233
    v_pk_mul_f32 v[66:67], v[66:67], s[24:25]
    v_cvt_pk_bf16_f32 v233, v66, v67
    v_lshlrev_b32 v68, 16, v234
    v_and_b32 v69, s27, v234
    v_pk_mul_f32 v[68:69], v[68:69], s[24:25]
    v_cvt_pk_bf16_f32 v234, v68, v69
    v_lshlrev_b32 v70, 16, v235
    v_and_b32 v71, s27, v235
    v_pk_mul_f32 v[70:71], v[70:71], s[24:25]
    v_cvt_pk_bf16_f32 v235, v70, v71
    ds_write_b128 v5, v[232:235] offset:24576
    v_lshlrev_b32 v64, 16, v236
    v_and_b32 v65, s27, v236
    v_pk_mul_f32 v[64:65], v[64:65], s[24:25]
    v_cvt_pk_bf16_f32 v236, v64, v65
    v_lshlrev_b32 v66, 16, v237
    v_and_b32 v67, s27, v237
    v_pk_mul_f32 v[66:67], v[66:67], s[24:25]
    v_cvt_pk_bf16_f32 v237, v66, v67
    v_lshlrev_b32 v68, 16, v238
    v_and_b32 v69, s27, v238
    v_pk_mul_f32 v[68:69], v[68:69], s[24:25]
    v_cvt_pk_bf16_f32 v238, v68, v69
    v_lshlrev_b32 v70, 16, v239
    v_and_b32 v71, s27, v239
    v_pk_mul_f32 v[70:71], v[70:71], s[24:25]
    v_cvt_pk_bf16_f32 v239, v70, v71
    ds_write_b128 v5, v[236:239] offset:28672
    v_lshlrev_b32 v72, 16, v240
    v_and_b32 v73, s27, v240
    v_pk_mul_f32 v[72:73], v[72:73], s[24:25]
    v_cvt_pk_bf16_f32 v240, v72, v73
    s_cmp_eq_u32 s18, 2
    s_cselect_b32 s24, 1.0, s24
    s_mov_b32 s25, s24
    s_nop 0
    v_lshlrev_b32 v74, 16, v241
    v_and_b32 v75, s27, v241
    v_pk_mul_f32 v[74:75], v[74:75], s[24:25]
    v_cvt_pk_bf16_f32 v241, v74, v75
    ds_write_b32 v9, v240
    ds_write_b32 v7, v241
    v_lshlrev_b32 v64, 16, v241
    v_and_b32 v65, s27, v241
    v_sub_f32 v64, v74, v64
    v_sub_f32 v65, v75, v65
    v_cvt_pk_bf16_f32 v67, v64, v65
    ds_write_b32 v7, v67 offset:256
    s_mov_b32 s40, 2304
    s_mov_b32 s41, 10496
    s_mov_b32 s42, 18688
    s_mov_b32 s43, 26880
    s_mov_b32 s44, 35072
    s_mov_b32 s24, 0xbf317218
    s_mov_b32 s25, 0xbf317218
    s_mov_b32 s50, 294912
    s_mov_b32 s51, 3571712
    s_mov_b32 s52, 262144
    s_cmp_eq_u32 s18, 1
    s_cbranch_scc1 PG4
    s_cmp_eq_u32 s18, 2
    s_cbranch_scc1 PG5
    s_cmp_eq_u32 s18, 3
    s_cbranch_scc1 PG6
K_WARM_RET2:
    s_waitcnt vmcnt(2)
    buffer_load_dword v8, v3, s[12:15], s36 offen sc1
    s_cmp_lg_u32 s18, 1
    s_waitcnt vmcnt(1) lgkmcnt(0)
    s_barrier
    s_cbranch_scc1 K_NOF3
    s_mov_b64 exec, 1
    buffer_store_dword v24, v24, s[12:15], s61 offen sc1
    s_mov_b64 exec, -1
K_NOF3:
    ds_read_b64_tr_b16 a[48:49], v56 offset:0
    ds_read_b64_tr_b16 a[50:51], v56 offset:1024
    ds_read_b64_tr_b16 a[52:53], v56 offset:2048
    ds_read_b64_tr_b16 a[54:55], v56 offset:3072
    ds_read_b64_tr_b16 a[56:57], v56 offset:4096
    ds_read_b64_tr_b16 a[58:59], v56 offset:5120
    ds_read_b64_tr_b16 a[60:61], v56 offset:6144
    ds_read_b64_tr_b16 a[62:63], v56 offset:7168
    ds_read_b64_tr_b16 a[64:65], v57 offset:0
    ds_read_b64_tr_b16 a[66:67], v57 offset:1024
    ds_read_b64_tr_b16 a[68:69], v57 offset:2048
    ds_read_b64_tr_b16 a[70:71], v57 offset:3072
    ds_read_b64_tr_b16 a[72:73], v57 offset:4096
    ds_read_b64_tr_b16 a[74:75], v57 offset:5120
    ds_read_b64_tr_b16 a[76:77], v57 offset:6144
    ds_read_b64_tr_b16 a[78:79], v57 offset:7168
    ds_read_b64_tr_b16 a[80:81], v58 offset:0
    ds_read_b64_tr_b16 a[82:83], v58 offset:1024
    ds_read_b64_tr_b16 a[84:85], v58 offset:2048
    ds_read_b64_tr_b16 a[86:87], v58 offset:3072
    ds_read_b64_tr_b16 a[88:89], v58 offset:4096
    ds_read_b64_tr_b16 a[90:91], v58 offset:5120
    ds_read_b64_tr_b16 a[92:93], v58 offset:6144
    ds_read_b64_tr_b16 a[94:95], v58 offset:7168
    ds_read_b64_tr_b16 a[96:97], v59 offset:0
    ds_read_b64_tr_b16 a[98:99], v59 offset:1024
    ds_read_b64_tr_b16 a[100:101], v59 offset:2048
    ds_read_b64_tr_b16 a[102:103], v59 offset:3072
    ds_read_b64_tr_b16 a[104:105], v59 offset:4096
    ds_read_b64_tr_b16 a[106:107], v59 offset:5120
    ds_read_b64_tr_b16 a[108:109], v59 offset:6144
    ds_read_b64_tr_b16 a[110:111], v59 offset:7168
    s_waitcnt vmcnt(1)
    s_cbranch_scc0 K_TW
    s_waitcnt vmcnt(0)
K_TW:
    v_cmp_eq_u32 vcc, -1, v8
    s_cbranch_vccnz K_TAB
K_TAB_RET:
    v_and_b32 v33, 0xffff, v8
    v_add_lshl_u32 v32, v44, v33, 2
    v_lshrrev_b32 v33, 16, v8
    v_subrev_u32 v33, 16, v33
    v_add_u32_dpp v170, v32, v30 quad_perm:[0,0,0,0] row_mask:0xf bank_mask:0xf
    buffer_load_dwordx4 v[64:67], v170, s[12:15], s50 offen sc1
    v_add_u32_dpp v171, v32, v30 quad_perm:[1,1,1,1] row_mask:0xf bank_mask:0xf
    buffer_load_dwordx4 v[68:71], v171, s[12:15], s50 offen sc1
    v_add_u32_dpp v172, v32, v30 quad_perm:[2,2,2,2] row_mask:0xf bank_mask:0xf
    buffer_load_dwordx4 v[72:75], v172, s[12:15], s50 offen sc1
    v_add_u32_dpp v173, v32, v30 quad_perm:[3,3,3,3] row_mask:0xf bank_mask:0xf
    buffer_load_dwordx4 v[76:79], v173, s[12:15], s50 offen sc1
    v_add_u32 v34, 0xc0000040, v32
    v_cmp_lt_i32 vcc, 0, v33
    v_cmp_lt_i32 s[46:47], 8, v33
    v_cmp_lt_i32 s[48:49], 16, v33
    v_mbcnt_lo_u32_b32 v35, vcc_lo, 0
    v_mbcnt_hi_u32_b32 v35, vcc_hi, v35
    v_mbcnt_lo_u32_b32 v35, s46, v35
    v_mbcnt_hi_u32_b32 v35, s47, v35
    v_mbcnt_lo_u32_b32 v35, s48, v35
    v_mbcnt_hi_u32_b32 v35, s49, v35
    v_cmp_gt_u32 s[36:37], 30, v35
    v_lshlrev_b32 v35, 3, v35
    v_add_u32 v45, 8, v35
    v_add_u32 v52, 16, v35
    v_add_u32 v40, 32, v34
    v_add_u32 v53, 64, v34
    s_and_b64 vcc, vcc, s[36:37]
    s_and_b64 s[46:47], s[46:47], s[36:37]
    s_and_b64 s[48:49], s[48:49], s[36:37]
    v_cndmask_b32 v35, 4, v35, vcc
    v_cndmask_b32 v45, 4, v45, s[46:47]
    v_cndmask_b32 v52, 4, v52, s[48:49]
    ds_permute_b32 v36, v35, v34
    ds_permute_b32 v40, v45, v40
    ds_permute_b32 v53, v52, v53
    v_cndmask_b32_e64 v35, 0, 24, vcc
    v_sub_u32 v33, v33, v35
    v_lshl_add_u32 v34, v35, 2, v34
    v_lshlrev_b32 v39, 1, v32
    v_lshlrev_b32 v37, 1, v32
    v_lshlrev_b32 v38, 1, v32
    s_nop 0
    v_mov_b32_dpp v37, v39 row_shr:4 row_mask:0xf bank_mask:0xa
    v_mov_b32_dpp v38, v39 row_shl:4 row_mask:0xf bank_mask:0x5
    s_nop 0
    v_add_u32_dpp v160, v37, v26 quad_perm:[0,0,0,0] row_mask:0xf bank_mask:0xf
    v_add_u32_dpp v161, v38, v26 quad_perm:[0,0,0,0] row_mask:0xf bank_mask:0xf
    v_add_u32_dpp v162, v37, v26 quad_perm:[1,1,1,1] row_mask:0xf bank_mask:0xf
    v_add_u32_dpp v163, v38, v26 quad_perm:[1,1,1,1] row_mask:0xf bank_mask:0xf
    v_add_u32_dpp v164, v37, v26 quad_perm:[2,2,2,2] row_mask:0xf bank_mask:0xf
    v_add_u32_dpp v165, v38, v26 quad_perm:[2,2,2,2] row_mask:0xf bank_mask:0xf
    v_add_u32_dpp v166, v37, v26 quad_perm:[3,3,3,3] row_mask:0xf bank_mask:0xf
    v_add_u32_dpp v167, v38, v26 quad_perm:[3,3,3,3] row_mask:0xf bank_mask:0xf
    s_waitcnt lgkmcnt(0)
    v_or3_b32 v36, v36, v40, v53
    v_lshlrev_b32 v39, 1, v36
    s_nop 0
    v_add_u32_dpp v174, v36, v31 quad_perm:[0,0,2,2] row_mask:0xf bank_mask:0xf
    buffer_load_dwordx4 v[80:83], v174, s[12:15], s50 offen sc1
    v_add_u32_dpp v168, v39, v27 quad_perm:[0,0,0,0] row_mask:0xf bank_mask:0xf
    v_add_u32_dpp v169, v39, v27 quad_perm:[2,2,2,2] row_mask:0xf bank_mask:0xf
    v_bfe_i32 v174, v174, 30, 1
    v_and_b32 v244, 0x3c0, v4
    v_bfe_u32 v245, v6, 1, 1
    v_lshl_add_u32 v244, v245, 10, v244
    v_and_b32 v245, 1, v6
    v_lshl_add_u32 v244, v245, 5, v244
    v_add_u32 v244, s23, v244
    v_add_u32 v245, 8, v244
    v_add_u32 v246, 16, v244
    v_add_u32 v247, 24, v244
    s_add_u32 s3, s38, 83200
    v_add_u32 v5, s3, v4
    s_mov_b32 s53, s27
    v_mul_u32_u24 v21, 196, v0
    v_add_u32 v21, 125184, v21
    v_cmp_gt_u32 s[38:39], s17, v0
    s_sub_u32 s27, 256, s17
    s_sub_u32 s19, s27, 32
    s_mov_b32 s20, 0
    ds_read_b64_tr_b16 a[112:113], v56 offset:16384
    ds_read_b64_tr_b16 a[114:115], v56 offset:17408
    ds_read_b64_tr_b16 a[116:117], v56 offset:18432
    ds_read_b64_tr_b16 a[118:119], v56 offset:19456
    ds_read_b64_tr_b16 a[120:121], v56 offset:20480
    ds_read_b64_tr_b16 a[122:123], v56 offset:21504
    ds_read_b64_tr_b16 a[124:125], v56 offset:22528
    ds_read_b64_tr_b16 a[126:127], v56 offset:23552
    ds_read_b64_tr_b16 a[128:129], v57 offset:16384
    ds_read_b64_tr_b16 a[130:131], v57 offset:17408
    ds_read_b64_tr_b16 a[132:133], v57 offset:18432
    ds_read_b64_tr_b16 a[134:135], v57 offset:19456
    ds_read_b64_tr_b16 a[136:137], v57 offset:20480
    ds_read_b64_tr_b16 a[138:139], v57 offset:21504
    ds_read_b64_tr_b16 a[140:141], v57 offset:22528
    ds_read_b64_tr_b16 a[142:143], v57 offset:23552
    ds_read_b64_tr_b16 a[144:145], v58 offset:16384
    ds_read_b64_tr_b16 a[146:147], v58 offset:17408
    ds_read_b64_tr_b16 a[148:149], v58 offset:18432
    ds_read_b64_tr_b16 a[150:151], v58 offset:19456
    ds_read_b64_tr_b16 a[152:153], v58 offset:20480
    ds_read_b64_tr_b16 a[154:155], v58 offset:21504
    ds_read_b64_tr_b16 a[156:157], v58 offset:22528
    ds_read_b64_tr_b16 a[158:159], v58 offset:23552
    ds_read_b64_tr_b16 a[160:161], v59 offset:16384
    ds_read_b64_tr_b16 a[162:163], v59 offset:17408
    ds_read_b64_tr_b16 a[164:165], v59 offset:18432
    ds_read_b64_tr_b16 a[166:167], v59 offset:19456
    ds_read_b64_tr_b16 a[168:169], v59 offset:20480
    ds_read_b64_tr_b16 a[170:171], v59 offset:21504
    ds_read_b64_tr_b16 a[172:173], v59 offset:22528
    ds_read_b64_tr_b16 a[174:175], v59 offset:23552
    ds_read_b64_tr_b16 a[176:177], v60 offset:0
    ds_read_b64_tr_b16 a[178:179], v60 offset:64
    ds_read_b64_tr_b16 a[180:181], v60 offset:128
    ds_read_b64_tr_b16 a[182:183], v60 offset:192
    ds_read_b64_tr_b16 a[254:255], v63
    v_mov_b32 v14, 0x3f803f80
    v_mov_b32 v15, 0
    ds_write_b64 v24, v[14:15]
    v_cmp_gt_u32 vcc, 32, v6
    v_mov_b32 v14, 0xffff
    s_nop 0
    v_cndmask_b32 v14, 0, v14, vcc
    v_bfe_u32 v92, v6, 4, 1
    v_lshlrev_b32 v92, 4, v92
    v_xor_b32 v225, v92, v26
    v_xor_b32 v227, 32, v225
    v_xor_b32 v229, 64, v225
    v_xor_b32 v231, 96, v225
    v_xor_b32 v233, 0, v225
    v_xor_b32 v235, 32, v225
    v_xor_b32 v237, 64, v225
    v_xor_b32 v239, 96, v225
    v_and_b32 v92, 3, v6
    v_mul_u32_u24 v208, 0x420, v92
    v_bfe_u32 v92, v6, 2, 3
    v_lshl_add_u32 v208, v92, 7, v208
    v_bfe_u32 v92, v6, 3, 1
    v_lshl_add_u32 v208, v92, 4, v208
    v_xor_b32 v208, v208, v1
    s_lshl_b32 s45, s18, 13
    s_add_u32 s45, s45, 46336
    v_add_u32 v208, s45, v208
    v_xor_b32 v209, 16, v208
    v_xor_b32 v210, 32, v208
    v_xor_b32 v211, 48, v208
    v_and_b32 v93, 31, v6
    s_lshl_b32 s3, s18, 7
    v_lshl_add_u32 v57, v93, 2, s3
    v_and_b32 v59, 0x38, v6
    v_lshl_add_u32 v59, v59, 1, s3
    s_sub_u32 s3, 896, s3
    v_lshl_add_u32 v58, v93, 2, s3
    s_barrier
    s_waitcnt vmcnt(4)
    s_add_u32 m0, s62, 0
    s_nop 0
    buffer_load_dwordx4 v55, s[4:7], 0 offen lds
    s_add_u32 m0, s62, 4096
    v_add_u32 v55, 0x1000, v55
    buffer_load_dwordx4 v55, s[4:7], 0 offen lds
    s_add_u32 m0, s62, 8192
    v_add_u32 v55, 0x1000, v55
    buffer_load_dwordx4 v55, s[4:7], 0 offen lds
    s_add_u32 m0, s62, 12288
    v_add_u32 v55, 0x1000, v55
    buffer_load_dwordx4 v55, s[4:7], 0 offen lds
    s_add_u32 m0, s62, 16384
    v_add_u32 v55, 0x1000, v55
    buffer_load_dwordx4 v55, s[4:7], 0 offen lds
    s_add_u32 m0, s62, 20480
    v_add_u32 v55, 0x1000, v55
    buffer_load_dwordx4 v55, s[4:7], 0 offen lds
    s_mov_b32 m0, s63
    v_add_u32 v55, 0x1000, v55
    buffer_load_dwordx4 v55, s[4:7], 0 offen lds
    v_mad_u32_u16 v96, v64, v28, s22
    v_mad_u32_u16 v97, v65, v28, s22
    v_mad_u32_u16 v98, v66, v28, s22
    v_mad_u32_u16 v99, v67, v28, s22
    ds_add_rtn_u32 v128, v96, v29
    v_add_u32_sdwa v64, v48, s40 dst_sel:WORD_0 dst_unused:UNUSED_PRESERVE src0_sel:DWORD src1_sel:DWORD
    ds_add_rtn_u32 v129, v97, v29
    v_add_u32_sdwa v65, v49, s40 dst_sel:WORD_0 dst_unused:UNUSED_PRESERVE src0_sel:DWORD src1_sel:DWORD
    ds_add_rtn_u32 v130, v98, v29
    v_add_u32_sdwa v66, v50, s40 dst_sel:WORD_0 dst_unused:UNUSED_PRESERVE src0_sel:DWORD src1_sel:DWORD
    ds_add_rtn_u32 v131, v99, v29
    v_add_u32_sdwa v67, v51, s40 dst_sel:WORD_0 dst_unused:UNUSED_PRESERVE src0_sel:DWORD src1_sel:DWORD
    s_waitcnt vmcnt(10)
    v_mad_u32_u16 v100, v68, v28, s22
    v_mad_u32_u16 v101, v69, v28, s22
    v_mad_u32_u16 v102, v70, v28, s22
    v_mad_u32_u16 v103, v71, v28, s22
    ds_add_rtn_u32 v132, v100, v29
    v_add_u32_sdwa v68, v48, s41 dst_sel:WORD_0 dst_unused:UNUSED_PRESERVE src0_sel:DWORD src1_sel:DWORD
    ds_add_rtn_u32 v133, v101, v29
    v_add_u32_sdwa v69, v49, s41 dst_sel:WORD_0 dst_unused:UNUSED_PRESERVE src0_sel:DWORD src1_sel:DWORD
    ds_add_rtn_u32 v134, v102, v29
    v_add_u32_sdwa v70, v50, s41 dst_sel:WORD_0 dst_unused:UNUSED_PRESERVE src0_sel:DWORD src1_sel:DWORD
    ds_add_rtn_u32 v135, v103, v29
    v_add_u32_sdwa v71, v51, s41 dst_sel:WORD_0 dst_unused:UNUSED_PRESERVE src0_sel:DWORD src1_sel:DWORD
    s_waitcnt vmcnt(9)
    v_mad_u32_u16 v104, v72, v28, s22
    v_mad_u32_u16 v105, v73, v28, s22
    v_mad_u32_u16 v106, v74, v28, s22
    v_mad_u32_u16 v107, v75, v28, s22
    ds_add_rtn_u32 v136, v104, v29
    v_add_u32_sdwa v72, v48, s42 dst_sel:WORD_0 dst_unused:UNUSED_PRESERVE src0_sel:DWORD src1_sel:DWORD
    ds_add_rtn_u32 v137, v105, v29
    v_add_u32_sdwa v73, v49, s42 dst_sel:WORD_0 dst_unused:UNUSED_PRESERVE src0_sel:DWORD src1_sel:DWORD
    ds_add_rtn_u32 v138, v106, v29
    v_add_u32_sdwa v74, v50, s42 dst_sel:WORD_0 dst_unused:UNUSED_PRESERVE src0_sel:DWORD src1_sel:DWORD
    ds_add_rtn_u32 v139, v107, v29
    v_add_u32_sdwa v75, v51, s42 dst_sel:WORD_0 dst_unused:UNUSED_PRESERVE src0_sel:DWORD src1_sel:DWORD
    s_waitcnt vmcnt(8)
    v_mad_u32_u16 v108, v76, v28, s22
    v_mad_u32_u16 v109, v77, v28, s22
    v_mad_u32_u16 v110, v78, v28, s22
    v_mad_u32_u16 v111, v79, v28, s22
    ds_add_rtn_u32 v140, v108, v29
    v_add_u32_sdwa v76, v48, s43 dst_sel:WORD_0 dst_unused:UNUSED_PRESERVE src0_sel:DWORD src1_sel:DWORD
    ds_add_rtn_u32 v141, v109, v29
    v_add_u32_sdwa v77, v49, s43 dst_sel:WORD_0 dst_unused:UNUSED_PRESERVE src0_sel:DWORD src1_sel:DWORD
    ds_add_rtn_u32 v142, v110, v29
    v_add_u32_sdwa v78, v50, s43 dst_sel:WORD_0 dst_unused:UNUSED_PRESERVE src0_sel:DWORD src1_sel:DWORD
    ds_add_rtn_u32 v143, v111, v29
    v_add_u32_sdwa v79, v51, s43 dst_sel:WORD_0 dst_unused:UNUSED_PRESERVE src0_sel:DWORD src1_sel:DWORD
    s_waitcnt vmcnt(7)
    v_or_b32 v80, v174, v80
    v_or_b32 v81, v174, v81
    v_or_b32 v82, v174, v82
    v_or_b32 v83, v174, v83
    v_mad_u32_u16 v112, v80, v28, s22
    v_mad_u32_u16 v113, v81, v28, s22
    v_mad_u32_u16 v114, v82, v28, s22
    v_mad_u32_u16 v115, v83, v28, s22
    ds_add_rtn_u32 v144, v112, v29
    v_add_u32_sdwa v80, v244, s44 dst_sel:WORD_0 dst_unused:UNUSED_PRESERVE src0_sel:DWORD src1_sel:DWORD
    ds_add_rtn_u32 v145, v113, v29
    v_add_u32_sdwa v81, v245, s44 dst_sel:WORD_0 dst_unused:UNUSED_PRESERVE src0_sel:DWORD src1_sel:DWORD
    ds_add_rtn_u32 v146, v114, v29
    v_add_u32_sdwa v82, v246, s44 dst_sel:WORD_0 dst_unused:UNUSED_PRESERVE src0_sel:DWORD src1_sel:DWORD
    ds_add_rtn_u32 v147, v115, v29
    v_add_u32_sdwa v83, v247, s44 dst_sel:WORD_0 dst_unused:UNUSED_PRESERVE src0_sel:DWORD src1_sel:DWORD
    v_cmp_lt_i32 vcc, 0, v33
    s_cbranch_vccnz K_MORE
K_MORE_RET:
    s_branch PG2E
K_TAB:
    s_mov_b32 s3, 400000
K_TAB_L:
    s_mov_b64 exec, vcc
    s_sleep 4
    buffer_load_dword v8, v3, s[12:15], s36 offen sc1
    s_sub_u32 s3, s3, 1
    s_cbranch_scc1 K_END
    s_waitcnt vmcnt(0)
    v_cmp_eq_u32 vcc, -1, v8
    s_cbranch_vccnz K_TAB_L
    s_mov_b64 exec, -1
    s_branch K_TAB_RET
.p2align 12
PG2:
    s_branch K_WARM_RET
K_F3:
    s_mov_b32 s3, 400000
K_F3_L:
    s_mov_b64 exec, vcc
    s_sleep 4
    buffer_load_dword v9, v41, s[12:15], s52 offen sc1
    s_sub_u32 s3, s3, 1
    s_cbranch_scc1 K_END
    s_waitcnt vmcnt(0)
    v_cmp_eq_u32 vcc, -1, v9
    s_cbranch_vccnz K_F3_L
    s_mov_b64 exec, -1
    s_branch K_F3_RET
PG2E:
    s_waitcnt lgkmcnt(0)
    s_barrier
    s_mov_b64 exec, s[38:39]
    ds_read_b32 v20, v21
    s_mov_b64 exec, -1
    buffer_load_dword v9, v41, s[12:15], s52 offen sc1
    s_waitcnt lgkmcnt(0)
    s_mov_b64 exec, s[38:39]
    v_cmp_lt_u32 vcc, 48, v20
    v_min_u32 v20, 63, v20
    v_sub_u32 v22, 63, v20
    v_lshlrev_b32 v22, 2, v22
    ds_add_rtn_u32 v23, v22, v29 offset:43264
    s_cbranch_vccz K_A1
    ds_write_b32 v24, v29 offset:44032
K_A1:
    s_mov_b64 exec, -1
    s_waitcnt lgkmcnt(0)
    s_barrier
    ds_read_b32 v25, v43 offset:43264
    v_min_u32 v128, 47, v128
    v_lshl_add_u32 v96, v128, 2, v96
    ds_write_b32 v96, v64 offset:4
    v_min_u32 v129, 47, v129
    v_lshl_add_u32 v97, v129, 2, v97
    ds_write_b32 v97, v65 offset:4
    v_min_u32 v130, 47, v130
    v_lshl_add_u32 v98, v130, 2, v98
    ds_write_b32 v98, v66 offset:4
    v_min_u32 v131, 47, v131
    v_lshl_add_u32 v99, v131, 2, v99
    ds_write_b32 v99, v67 offset:4
    s_waitcnt lgkmcnt(4)
    v_mov_b32 v46, v25
    v_min_u32 v132, 47, v132
    v_lshl_add_u32 v100, v132, 2, v100
    v_add_u32_dpp v46, v46, v46 row_shr:1 row_mask:0xf bank_mask:0xf bound_ctrl:0
    ds_write_b32 v100, v68 offset:4
    v_min_u32 v133, 47, v133
    v_add_u32_dpp v46, v46, v46 row_shr:2 row_mask:0xf bank_mask:0xf bound_ctrl:0
    v_lshl_add_u32 v101, v133, 2, v101
    ds_write_b32 v101, v69 offset:4
    v_add_u32_dpp v46, v46, v46 row_shr:4 row_mask:0xf bank_mask:0xf bound_ctrl:0
    v_min_u32 v134, 47, v134
    v_lshl_add_u32 v102, v134, 2, v102
    v_add_u32_dpp v46, v46, v46 row_shr:8 row_mask:0xf bank_mask:0xf bound_ctrl:0
    ds_write_b32 v102, v70 offset:4
    v_min_u32 v135, 47, v135
    v_add_u32_dpp v46, v46, v46 row_bcast:15 row_mask:0xa bank_mask:0xf
    v_lshl_add_u32 v103, v135, 2, v103
    ds_write_b32 v103, v71 offset:4
    v_add_u32_dpp v46, v46, v46 row_bcast:31 row_mask:0xc bank_mask:0xf
    v_sub_u32 v46, v46, v25
    ds_bpermute_b32 v46, v22, v46
    v_lshrrev_b32 v30, 1, v20
    v_cmp_lt_u32 s[36:37], 26, v20
    v_lshlrev_b32 v84, 16, v148
    v_and_b32 v85, s53, v148
    v_pk_mul_f32 v[84:85], v[84:85], s[24:25]
    v_cvt_pk_bf16_f32 v148, v84, v85
    v_lshlrev_b32 v86, 16, v149
    v_and_b32 v87, s53, v149
    v_pk_mul_f32 v[86:87], v[86:87], s[24:25]
    v_cvt_pk_bf16_f32 v149, v86, v87
    v_lshlrev_b32 v88, 16, v150
    v_and_b32 v89, s53, v150
    v_pk_mul_f32 v[88:89], v[88:89], s[24:25]
    v_cvt_pk_bf16_f32 v150, v88, v89
    v_lshlrev_b32 v90, 16, v151
    v_and_b32 v91, s53, v151
    v_pk_mul_f32 v[90:91], v[90:91], s[24:25]
    v_cvt_pk_bf16_f32 v151, v90, v91
    ds_write_b128 v5, v[148:151] offset:0
    v_lshlrev_b32 v84, 16, v152
    v_and_b32 v85, s53, v152
    v_pk_mul_f32 v[84:85], v[84:85], s[24:25]
    v_cvt_pk_bf16_f32 v152, v84, v85
    v_lshlrev_b32 v86, 16, v153
    v_and_b32 v87, s53, v153
    v_pk_mul_f32 v[86:87], v[86:87], s[24:25]
    v_cvt_pk_bf16_f32 v153, v86, v87
    v_lshlrev_b32 v88, 16, v154
    v_and_b32 v89, s53, v154
    v_pk_mul_f32 v[88:89], v[88:89], s[24:25]
    v_cvt_pk_bf16_f32 v154, v88, v89
    v_lshlrev_b32 v90, 16, v155
    v_and_b32 v91, s53, v155
    v_pk_mul_f32 v[90:91], v[90:91], s[24:25]
    v_cvt_pk_bf16_f32 v155, v90, v91
    ds_write_b128 v5, v[152:155] offset:1024
    v_lshlrev_b32 v84, 16, v156
    v_and_b32 v85, s53, v156
    v_pk_mul_f32 v[84:85], v[84:85], s[24:25]
    v_cvt_pk_bf16_f32 v156, v84, v85
    v_lshlrev_b32 v86, 16, v157
    v_and_b32 v87, s53, v157
    v_pk_mul_f32 v[86:87], v[86:87], s[24:25]
    v_cvt_pk_bf16_f32 v157, v86, v87
    v_lshlrev_b32 v88, 16, v158
    v_and_b32 v89, s53, v158
    v_pk_mul_f32 v[88:89], v[88:89], s[24:25]
    v_cvt_pk_bf16_f32 v158, v88, v89
    v_lshlrev_b32 v90, 16, v159
    v_and_b32 v91, s53, v159
    v_pk_mul_f32 v[90:91], v[90:91], s[24:25]
    v_cvt_pk_bf16_f32 v159, v90, v91
    ds_write_b128 v5, v[156:159] offset:2048
    v_lshlrev_b32 v84, 16, v248
    v_and_b32 v85, s53, v248
    v_pk_mul_f32 v[84:85], v[84:85], s[24:25]
    v_cvt_pk_bf16_f32 v248, v84, v85
    v_lshlrev_b32 v86, 16, v249
    v_and_b32 v87, s53, v249
    v_pk_mul_f32 v[86:87], v[86:87], s[24:25]
    v_cvt_pk_bf16_f32 v249, v86, v87
    v_lshlrev_b32 v88, 16, v250
    v_and_b32 v89, s53, v250
    v_pk_mul_f32 v[88:89], v[88:89], s[24:25]
    v_cvt_pk_bf16_f32 v250, v88, v89
    v_lshlrev_b32 v90, 16, v251
    v_and_b32 v91, s53, v251
    v_pk_mul_f32 v[90:91], v[90:91], s[24:25]
    v_cvt_pk_bf16_f32 v251, v90, v91
    ds_write_b128 v5, v[248:251] offset:3072
    s_waitcnt vmcnt(0)
    v_cmp_eq_u32 vcc, -1, v9
    s_cbranch_vccnz K_F3
K_F3_RET:
    s_cmp_lg_u32 s20, 0
    s_cbranch_scc1 K_MEA
K_MEA_RET:
    s_add_u32 m0, s23, 2304
    s_nop 0
    buffer_load_dwordx4 v160, s[12:15], s51 offen sc1 lds
    s_add_u32 m0, s23, 3328
    s_nop 0
    buffer_load_dwordx4 v161, s[12:15], s51 offen sc1 lds
    s_add_u32 m0, s23, 10496
    s_nop 0
    buffer_load_dwordx4 v162, s[12:15], s51 offen sc1 lds
    s_waitcnt lgkmcnt(0)
    v_add_u32 v23, v23, v46
    v_cmp_gt_u32 vcc, s19, v23
    v_lshlrev_b32 v33, 1, v23
    v_lshlrev_b32 v34, 2, v23
    v_cndmask_b32_e64 v31, 8, 10, vcc
    v_cndmask_b32 v31, v31, v30, s[36:37]
    v_cmp_gt_u32 vcc, s27, v23
    v_cmp_gt_u32 s[36:37], v20, v31
    v_mov_b32 v35, 0xff
    v_sub_u32 v37, 63, v31
    s_and_b64 vcc, vcc, s[36:37]
    s_and_b64 vcc, vcc, s[38:39]
    v_cndmask_b32 v32, 0, v31, vcc
    v_sub_u32 v32, v20, v32
    v_sub_u32 v36, 63, v32
    v_lshlrev_b32 v36, 2, v36
    v_lshlrev_b32 v37, 2, v37
    s_mov_b64 exec, s[38:39]
    ds_add_rtn_u32 v38, v36, v29 offset:43520
    s_mov_b64 exec, vcc
    ds_add_rtn_u32 v39, v37, v29 offset:43520
    v_add_lshl_u32 v47, s16, v0, 7
    ds_write_b32 v34, v47 offset:43776
    s_mov_b64 exec, -1
    v_cndmask_b32 v35, v35, v33, vcc
    v_lshl_or_b32 v48, v35, 8, v32
    v_lshl_or_b32 v48, v48, 16, v0
    v_or_b32 v33, 1, v33
    v_lshl_or_b32 v49, v33, 8, v31
    v_lshl_or_b32 v49, v49, 8, v32
    v_lshl_or_b32 v49, v49, 8, v0
    v_lshl_add_u32 v50, v32, 2, v21
    s_mov_b64 s[46:47], vcc
    s_add_u32 m0, s23, 11520
    s_nop 0
    buffer_load_dwordx4 v163, s[12:15], s51 offen sc1 lds
    s_add_u32 m0, s23, 18688
    s_nop 0
    buffer_load_dwordx4 v164, s[12:15], s51 offen sc1 lds
    s_add_u32 m0, s23, 19712
    s_nop 0
    buffer_load_dwordx4 v165, s[12:15], s51 offen sc1 lds
    s_waitcnt lgkmcnt(0)
    s_barrier
    ds_read_b32 v25, v43 offset:43520
    v_min_u32 v136, 47, v136
    v_lshl_add_u32 v104, v136, 2, v104
    ds_write_b32 v104, v72 offset:4
    v_min_u32 v137, 47, v137
    v_lshl_add_u32 v105, v137, 2, v105
    ds_write_b32 v105, v73 offset:4
    v_min_u32 v138, 47, v138
    v_lshl_add_u32 v106, v138, 2, v106
    ds_write_b32 v106, v74 offset:4
    v_min_u32 v139, 47, v139
    v_lshl_add_u32 v107, v139, 2, v107
    ds_write_b32 v107, v75 offset:4
    s_waitcnt lgkmcnt(4)
    v_mov_b32 v46, v25
    v_min_u32 v140, 47, v140
    v_lshl_add_u32 v108, v140, 2, v108
    v_add_u32_dpp v46, v46, v46 row_shr:1 row_mask:0xf bank_mask:0xf bound_ctrl:0
    ds_write_b32 v108, v76 offset:4
    v_min_u32 v141, 47, v141
    v_add_u32_dpp v46, v46, v46 row_shr:2 row_mask:0xf bank_mask:0xf bound_ctrl:0
    v_lshl_add_u32 v109, v141, 2, v109
    ds_write_b32 v109, v77 offset:4
    v_add_u32_dpp v46, v46, v46 row_shr:4 row_mask:0xf bank_mask:0xf bound_ctrl:0
    v_min_u32 v142, 47, v142
    v_lshl_add_u32 v110, v142, 2, v110
    v_add_u32_dpp v46, v46, v46 row_shr:8 row_mask:0xf bank_mask:0xf bound_ctrl:0
    ds_write_b32 v110, v78 offset:4
    v_min_u32 v143, 47, v143
    v_add_u32_dpp v46, v46, v46 row_bcast:15 row_mask:0xa bank_mask:0xf
    v_lshl_add_u32 v111, v143, 2, v111
    ds_write_b32 v111, v79 offset:4
    v_add_u32_dpp v46, v46, v46 row_bcast:31 row_mask:0xc bank_mask:0xf
    v_sub_u32 v46, v46, v25
    ds_bpermute_b32 v36, v36, v46
    ds_bpermute_b32 v37, v37, v46
    v_min_u32 v144, 47, v144
    v_lshl_add_u32 v112, v144, 2, v112
    ds_write_b32 v112, v80 offset:4
    v_min_u32 v145, 47, v145
    v_lshl_add_u32 v113, v145, 2, v113
    ds_write_b32 v113, v81 offset:4
    v_min_u32 v146, 47, v146
    v_lshl_add_u32 v114, v146, 2, v114
    ds_write_b32 v114, v82 offset:4
    v_min_u32 v147, 47, v147
    v_lshl_add_u32 v115, v147, 2, v115
    ds_write_b32 v115, v83 offset:4
    s_waitcnt lgkmcnt(4)
    v_add_lshl_u32 v36, v36, v38, 2
    v_add_lshl_u32 v37, v37, v39, 2
    s_mov_b64 exec, s[38:39]
    ds_write2st64_b32 v36, v48, v21 offset0:173 offset1:177
    s_mov_b64 exec, s[46:47]
    ds_write2st64_b32 v37, v49, v50 offset0:173 offset1:177
    s_mov_b64 exec, -1
    s_add_u32 m0, s23, 26880
    s_nop 0
    buffer_load_dwordx4 v166, s[12:15], s51 offen sc1 lds
    s_add_u32 m0, s23, 27904
    s_nop 0
    buffer_load_dwordx4 v167, s[12:15], s51 offen sc1 lds
    s_add_u32 m0, s23, 35072
    s_nop 0
    buffer_load_dwordx4 v168, s[12:15], s51 offen sc1 lds
    s_add_u32 m0, s23, 36096
    s_nop 0
    buffer_load_dwordx4 v169, s[12:15], s51 offen sc1 lds
    s_movk_i32 s54, 0xff
    s_movk_i32 s55, 144
    s_movk_i32 s59, 128
    s_mov_b32 s57, 0x0d800000
    s_movk_i32 s58, 0x207
    v_add_u32 v6, 99584, v1
    s_mov_b32 s28, s4
    s_or_b32 s29, s5, 0x800000
    s_mov_b32 s30, 50000
    s_waitcnt vmcnt(11) lgkmcnt(0)
    s_barrier
    ds_read_b128 v[20:23], v59 offset:45312
    ds_read2st64_b32 v[26:27], v57 offset0:173 offset1:177
    ds_read_b32 v7, v58 offset:44288
    ds_read_b32 v8, v58 offset:45312
    ds_read_b32 v24, v24 offset:44032
    v_mov_b32 v34, v208
    v_mov_b32 v35, v209
    v_mov_b32 v36, v210
    v_mov_b32 v37, v211
    s_waitcnt lgkmcnt(3)
    ds_read_u16 v224, v20 offset:6
    ds_read_u16 v226, v21 offset:6
    ds_read_u16 v228, v22 offset:6
    ds_read_u16 v230, v23 offset:6
    v_and_b32 v28, s54, v26
    v_and_b32 v29, 7, v26
    v_lshl_add_u32 v28, v28, 7, v6
    v_lshlrev_b32 v29, 4, v29
    v_xor_b32 v28, v28, v29
    v_xor_b32 v29, 16, v28
    v_xor_b32 v30, 32, v28
    v_xor_b32 v31, 48, v28
    ds_read_b128 a[32:35], v28
    ds_read_b128 a[36:39], v29
    ds_read_b128 a[40:43], v30
    ds_read_b128 a[44:47], v31
    ds_read_u16 v232, v20 offset:10
    ds_read_u16 v234, v21 offset:10
    ds_read_u16 v236, v22 offset:10
    ds_read_u16 v238, v23 offset:10
    s_waitcnt lgkmcnt(8)
    s_add_u32 m0, s45, 0
    v_mov_b32 v5, v26
    buffer_load_dwordx4 v[224:225], s[28:31], 0 idxen offen lds
    s_add_u32 m0, s45, 1024
    v_mov_b32 v2, v27
    buffer_load_dwordx4 v[226:227], s[28:31], 0 idxen offen lds
    s_add_u32 m0, s45, 2048
    v_bfe_u32 v3, v26, 16, 8
    buffer_load_dwordx4 v[228:229], s[28:31], 0 idxen offen lds
    s_add_u32 m0, s45, 3072
    v_cmp_ne_u32 vcc, 0, v24
    buffer_load_dwordx4 v[230:231], s[28:31], 0 idxen offen lds
    s_waitcnt lgkmcnt(0)
    s_cbranch_vccnz K_SLOW0
.p2align 3
    v_mfma_f32_32x32x16_bf16 v[192:207], a[112:115], a[32:35], 0
    ds_read2_b32 v[40:41], v2 offset0:1 offset1:2
    ds_read2_b32 v[42:43], v2 offset0:3 offset1:4
    ds_read2_b32 v[10:11], v8 offset0:1 offset1:2
    ds_read2_b32 v[12:13], v8 offset0:3 offset1:4
    v_mfma_f32_32x32x16_bf16 v[192:207], a[116:119], a[36:39], v[192:207]
    v_readfirstlane_b32 s20, v3
    v_and_b32 v9, s54, v7
    v_and_b32 v29, 7, v7
    v_lshl_add_u32 v9, v9, 7, v6
    v_lshlrev_b32 v29, 4, v29
    v_xor_b32 v9, v9, v29
    v_mfma_f32_32x32x16_bf16 v[192:207], a[120:123], a[40:43], v[192:207]
    ds_read_b64_tr_b16 a[184:185], v62 offset:0
    ds_read_b64_tr_b16 a[186:187], v62 offset:1024
    ds_read_b64_tr_b16 a[188:189], v62 offset:32
    ds_read_b64_tr_b16 a[190:191], v62 offset:1056
    ds_read_b64_tr_b16 a[192:193], v62 offset:2048
    ds_read_b64_tr_b16 a[194:195], v62 offset:3072
    v_mfma_f32_32x32x16_bf16 v[192:207], a[124:127], a[44:47], v[192:207]
    s_add_u32 m0, s45, 4096
    s_nop 0
    buffer_load_dwordx4 v[232:233], s[28:31], 0 idxen offen lds
    v_mfma_f32_32x32x16_bf16 v[208:223], a[128:131], a[32:35], 0
    s_add_u32 m0, s45, 5120
    s_nop 0
    buffer_load_dwordx4 v[234:235], s[28:31], 0 idxen offen lds
    v_mfma_f32_32x32x16_bf16 v[208:223], a[132:135], a[36:39], v[208:223]
    s_add_u32 m0, s45, 6144
    s_nop 0
    buffer_load_dwordx4 v[236:237], s[28:31], 0 idxen offen lds
    v_mfma_f32_32x32x16_bf16 v[208:223], a[136:139], a[40:43], v[208:223]
    s_add_u32 m0, s45, 7168
    s_nop 0
    buffer_load_dwordx4 v[238:239], s[28:31], 0 idxen offen lds
    v_mfma_f32_32x32x16_bf16 v[208:223], a[140:143], a[44:47], v[208:223]
    s_waitcnt lgkmcnt(0)
    v_and_b32 v44, v14, v40
    v_and_b32 v45, v14, v41
    v_and_b32 v46, v14, v42
    v_and_b32 v4, v14, v43
    v_mad_u32_u16 v0, v42, s59, v1 op_sel:[1,0,0,0]
    v_mfma_f32_32x32x16_bf16 v[224:239], a[144:147], a[32:35], 0
    ds_read_b64_tr_b16 a[196:197], v62 offset:2080
    ds_read_b64_tr_b16 a[198:199], v62 offset:3104
    ds_read_b64_tr_b16 a[200:201], v62 offset:4096
    ds_read_b64_tr_b16 a[202:203], v62 offset:5120
    ds_read_b64_tr_b16 a[204:205], v62 offset:4128
    ds_read_b64_tr_b16 a[206:207], v62 offset:5152
    ds_read_b64_tr_b16 a[208:209], v62 offset:6144
    ds_read_b64_tr_b16 a[210:211], v62 offset:7168
    v_mfma_f32_32x32x16_bf16 v[224:239], a[148:151], a[36:39], v[224:239]
    ds_read_b64_tr_b16 a[212:213], v62 offset:6176
    ds_read_b64_tr_b16 a[214:215], v62 offset:7200
    ds_read_b64_tr_b16 a[216:217], v62 offset:8192
    ds_read_b64_tr_b16 a[218:219], v62 offset:9216
    ds_read_b64_tr_b16 a[220:221], v62 offset:8224
    ds_read_b64_tr_b16 a[222:223], v62 offset:9248
    ds_read_b64_tr_b16 a[224:225], v62 offset:10240
    ds_read_b64_tr_b16 a[226:227], v62 offset:11264
    ds_read_b64_tr_b16 a[228:229], v62 offset:10272
    v_mfma_f32_32x32x16_bf16 v[224:239], a[152:155], a[40:43], v[224:239]
    ds_read_b64_tr_b16 a[230:231], v62 offset:11296
    ds_read_b64_tr_b16 a[232:233], v62 offset:12288
    ds_read_b64_tr_b16 a[234:235], v62 offset:13312
    ds_read_b64_tr_b16 a[236:237], v62 offset:12320
    ds_read_b64_tr_b16 a[238:239], v62 offset:13344
    ds_read_b64_tr_b16 a[240:241], v62 offset:14336
    ds_read_b64_tr_b16 a[242:243], v62 offset:15360
    ds_read_b64_tr_b16 a[244:245], v62 offset:14368
    ds_read_b64_tr_b16 a[246:247], v62 offset:15392
    v_mfma_f32_32x32x16_bf16 v[224:239], a[156:159], a[44:47], v[224:239]
    s_max_u32 s20, s20, 2
    s_sub_u32 s37, s20, 3
    s_sub_u32 s20, s20, 1
    s_mov_b32 s19, 1
    s_lshl_b32 s45, s18, 5
    s_add_u32 s45, s45, 128
    s_mul_i32 s46, s18, 4608
    s_add_u32 s46, s46, 64768
    s_movk_i32 s47, 576
    s_mov_b32 s48, 43776
    s_mov_b32 s27, 0xffff0000
    s_waitcnt vmcnt(4)
    s_barrier
    v_mfma_f32_32x32x16_bf16 v[240:255], a[160:163], a[32:35], 0
    ds_read_b128 a[0:3], v34 offset:0
    ds_read_b128 a[4:7], v35 offset:0
    ds_read_b128 a[8:11], v36 offset:0
    ds_read_b128 a[12:15], v37 offset:0
    v_mfma_f32_32x32x16_bf16 v[240:255], a[164:167], a[36:39], v[240:255]
    ds_read_b64 a[248:249], v44
    ds_read_b64 a[250:251], v45
    ds_read_b64 a[252:253], v46
    v_mfma_f32_32x32x16_bf16 v[240:255], a[168:171], a[40:43], v[240:255]
    v_mfma_f32_32x32x16_bf16 v[240:255], a[172:175], a[44:47], v[240:255]
.p2align 3
    s_waitcnt lgkmcnt(0)
    s_nop 0
    v_mfma_f32_32x32x16_bf16 v[64:79], a[48:51], a[0:3], v[192:207]
    buffer_load_dwordx4 a[32:35], v0, s[4:7], 0 offen offset:0
    v_mfma_f32_32x32x16_bf16 v[64:79], a[52:55], a[4:7], v[64:79]
    buffer_load_dwordx4 a[36:39], v0, s[4:7], 0 offen offset:16
    v_mfma_f32_32x32x16_bf16 v[64:79], a[56:59], a[8:11], v[64:79]
    buffer_load_dwordx4 a[40:43], v0, s[4:7], 0 offen offset:32
    v_mfma_f32_32x32x16_bf16 v[64:79], a[60:63], a[12:15], v[64:79]
    buffer_load_dwordx4 a[44:47], v0, s[4:7], 0 offen offset:48
    v_mfma_f32_32x32x8_bf16 v[64:79], a[176:177], a[248:249], v[64:79]
    v_mad_u32_u16 v0, v43, s59, v1 op_sel:[1,0,0,0]
    s_nop 8
    s_nop 0
    v_mfma_f32_32x32x16_bf16 v[80:95], a[64:67], a[0:3], v[208:223]
    v_exp_f32 v128, v64
    v_exp_f32 v129, v65
    v_exp_f32_e64 v130, v66
    v_mfma_f32_32x32x16_bf16 v[80:95], a[68:71], a[4:7], v[80:95]
    v_exp_f32 v131, v67
    v_exp_f32 v132, v68
    v_exp_f32_e64 v133, v69
    v_mfma_f32_32x32x16_bf16 v[80:95], a[72:75], a[8:11], v[80:95]
    v_exp_f32 v134, v70
    v_exp_f32 v135, v71
    v_exp_f32_e64 v136, v72
    v_mfma_f32_32x32x16_bf16 v[80:95], a[76:79], a[12:15], v[80:95]
    v_exp_f32 v137, v73
    v_exp_f32 v138, v74
    v_exp_f32_e64 v139, v75
    v_mfma_f32_32x32x8_bf16 v[80:95], a[178:179], a[248:249], v[80:95]
    v_exp_f32 v140, v76
    v_exp_f32 v141, v77
    v_exp_f32 v142, v78
    v_exp_f32 v143, v79
    v_pk_add_f32 v[128:129], v[128:129], 1.0 op_sel_hi:[1,0]
    v_pk_add_f32 v[130:131], v[130:131], 1.0 op_sel_hi:[1,0]
    v_pk_add_f32 v[132:133], v[132:133], 1.0 op_sel_hi:[1,0]
    v_pk_add_f32 v[134:135], v[134:135], 1.0 op_sel_hi:[1,0]
    v_pk_add_f32 v[136:137], v[136:137], 1.0 op_sel_hi:[1,0]
    v_pk_add_f32 v[138:139], v[138:139], 1.0 op_sel_hi:[1,0]
    v_pk_add_f32 v[140:141], v[140:141], 1.0 op_sel_hi:[1,0]
    v_pk_add_f32 v[142:143], v[142:143], 1.0 op_sel_hi:[1,0]
    v_mfma_f32_32x32x16_bf16 v[96:111], a[80:83], a[0:3], v[224:239]
    v_exp_f32 v144, v80
    v_exp_f32 v145, v81
    v_exp_f32_e64 v146, v82
    v_mfma_f32_32x32x16_bf16 v[96:111], a[84:87], a[4:7], v[96:111]
    v_exp_f32 v147, v83
    v_exp_f32 v148, v84
    v_exp_f32_e64 v149, v85
    v_mfma_f32_32x32x16_bf16 v[96:111], a[88:91], a[8:11], v[96:111]
    v_exp_f32 v150, v86
    v_exp_f32 v151, v87
    v_exp_f32_e64 v152, v88
    v_mfma_f32_32x32x16_bf16 v[96:111], a[92:95], a[12:15], v[96:111]
    v_exp_f32 v153, v89
    v_exp_f32 v154, v90
    v_exp_f32_e64 v155, v91
    v_mfma_f32_32x32x8_bf16 v[96:111], a[180:181], a[248:249], v[96:111]
    v_exp_f32 v156, v92
    v_exp_f32 v157, v93
    v_exp_f32 v158, v94
    v_exp_f32 v159, v95
    v_pk_add_f32 v[144:145], v[144:145], 1.0 op_sel_hi:[1,0]
    v_pk_add_f32 v[146:147], v[146:147], 1.0 op_sel_hi:[1,0]
    v_pk_add_f32 v[148:149], v[148:149], 1.0 op_sel_hi:[1,0]
    v_pk_add_f32 v[150:151], v[150:151], 1.0 op_sel_hi:[1,0]
    v_pk_add_f32 v[152:153], v[152:153], 1.0 op_sel_hi:[1,0]
    v_pk_add_f32 v[154:155], v[154:155], 1.0 op_sel_hi:[1,0]
    v_pk_add_f32 v[156:157], v[156:157], 1.0 op_sel_hi:[1,0]
    v_pk_add_f32 v[158:159], v[158:159], 1.0 op_sel_hi:[1,0]
    v_mfma_f32_32x32x16_bf16 v[112:127], a[96:99], a[0:3], v[240:255]
    s_waitcnt vmcnt(4)
    v_exp_f32 v160, v96
    v_exp_f32 v161, v97
    v_exp_f32 v162, v98
    v_mfma_f32_32x32x16_bf16 v[112:127], a[100:103], a[4:7], v[112:127]
    ds_read_b128 a[16:19], v34 offset:4096
    ds_read_b128 a[20:23], v35 offset:4096
    v_exp_f32 v163, v99
    v_exp_f32 v164, v100
    v_exp_f32_e64 v165, v101
    v_mfma_f32_32x32x16_bf16 v[112:127], a[104:107], a[8:11], v[112:127]
    ds_read_b128 a[24:27], v36 offset:4096
    ds_read_b128 a[28:31], v37 offset:4096
    v_exp_f32 v166, v102
    v_exp_f32 v167, v103
    v_exp_f32_e64 v168, v104
    v_mfma_f32_32x32x16_bf16 v[112:127], a[108:111], a[12:15], v[112:127]
    buffer_load_dwordx4 a[0:3], v0, s[4:7], 0 offen offset:0
    v_exp_f32 v169, v105
    v_exp_f32 v170, v106
    v_exp_f32_e64 v171, v107
    v_mfma_f32_32x32x8_bf16 v[112:127], a[182:183], a[248:249], v[112:127]
    v_exp_f32 v172, v108
    v_exp_f32 v173, v109
    v_exp_f32 v174, v110
    v_exp_f32 v175, v111
    v_pk_add_f32 v[160:161], v[160:161], 1.0 op_sel_hi:[1,0]
    v_pk_add_f32 v[162:163], v[162:163], 1.0 op_sel_hi:[1,0]
    v_pk_add_f32 v[164:165], v[164:165], 1.0 op_sel_hi:[1,0]
    v_pk_add_f32 v[166:167], v[166:167], 1.0 op_sel_hi:[1,0]
    v_pk_add_f32 v[168:169], v[168:169], 1.0 op_sel_hi:[1,0]
    v_pk_add_f32 v[170:171], v[170:171], 1.0 op_sel_hi:[1,0]
    v_pk_add_f32 v[172:173], v[172:173], 1.0 op_sel_hi:[1,0]
    v_pk_add_f32 v[174:175], v[174:175], 1.0 op_sel_hi:[1,0]
    s_waitcnt lgkmcnt(0)
    s_barrier
    v_mfma_f32_32x32x16_bf16 v[16:31], a[48:51], a[16:19], v[192:207]
    v_exp_f32 v176, v112
    v_exp_f32 v177, v113
    v_exp_f32_e64 v178, v114
    v_mfma_f32_32x32x16_bf16 v[16:31], a[52:55], a[20:23], v[16:31]
    v_exp_f32 v179, v115
    v_exp_f32 v180, v116
    v_exp_f32_e64 v181, v117
    v_mfma_f32_32x32x16_bf16 v[16:31], a[56:59], a[24:27], v[16:31]
    v_exp_f32 v182, v118
    v_exp_f32 v183, v119
    v_exp_f32_e64 v184, v120
    v_mfma_f32_32x32x16_bf16 v[16:31], a[60:63], a[28:31], v[16:31]
    buffer_load_dwordx4 a[4:7], v0, s[4:7], 0 offen offset:16
    v_exp_f32 v185, v121
    v_exp_f32 v186, v122
    v_exp_f32_e64 v187, v123
    v_mfma_f32_32x32x8_bf16 v[16:31], a[176:177], a[250:251], v[16:31]
    v_exp_f32 v188, v124
    v_exp_f32 v189, v125
    v_exp_f32 v190, v126
    v_exp_f32 v191, v127
    v_pk_add_f32 v[176:177], v[176:177], 1.0 op_sel_hi:[1,0]
    v_pk_add_f32 v[178:179], v[178:179], 1.0 op_sel_hi:[1,0]
    v_pk_add_f32 v[180:181], v[180:181], 1.0 op_sel_hi:[1,0]
    v_pk_add_f32 v[182:183], v[182:183], 1.0 op_sel_hi:[1,0]
    v_pk_add_f32 v[184:185], v[184:185], 1.0 op_sel_hi:[1,0]
    v_pk_add_f32 v[186:187], v[186:187], 1.0 op_sel_hi:[1,0]
    v_pk_add_f32 v[188:189], v[188:189], 1.0 op_sel_hi:[1,0]
    v_pk_add_f32 v[190:191], v[190:191], 1.0 op_sel_hi:[1,0]
    s_branch K_A0
.p2align 12
PG3:
    s_branch K_WARM_RET
    s_nop 0
K_LOOP0:
    buffer_load_dwordx4 a[0:3], v0, s[4:7], 0 offen offset:0
    v_exp_f32 v60, v28
    v_exp_f32 v61, v29
    v_exp_f32 v62, v30
    v_exp_f32 v63, v31
    v_pk_fma_f32 v[96:97], v[96:97], v[48:49], v[96:97]
    v_pk_fma_f32 v[98:99], v[98:99], v[50:51], v[98:99]
    v_pk_fma_f32 v[100:101], v[100:101], v[52:53], v[100:101]
    v_pk_fma_f32 v[102:103], v[102:103], v[54:55], v[102:103]
    v_pk_fma_f32 v[104:105], v[104:105], v[56:57], v[104:105]
    v_pk_fma_f32 v[106:107], v[106:107], v[58:59], v[106:107]
    v_pk_fma_f32 v[108:109], v[108:109], v[60:61], v[108:109]
    v_pk_fma_f32 v[110:111], v[110:111], v[62:63], v[110:111]
    v_pk_fma_f32 v[96:97], v[16:17], v[160:161], v[96:97]
    v_pk_fma_f32 v[98:99], v[18:19], v[162:163], v[98:99]
    v_pk_fma_f32 v[100:101], v[20:21], v[164:165], v[100:101]
    v_pk_fma_f32 v[102:103], v[22:23], v[166:167], v[102:103]
    v_pk_fma_f32 v[104:105], v[24:25], v[168:169], v[104:105]
    v_pk_fma_f32 v[106:107], v[26:27], v[170:171], v[106:107]
    v_pk_fma_f32 v[108:109], v[28:29], v[172:173], v[108:109]
    v_pk_fma_f32 v[110:111], v[30:31], v[174:175], v[110:111]
    v_pk_fma_f32 v[160:161], v[160:161], v[48:49], v[160:161]
    v_pk_fma_f32 v[162:163], v[162:163], v[50:51], v[162:163]
    v_pk_fma_f32 v[164:165], v[164:165], v[52:53], v[164:165]
    v_pk_fma_f32 v[166:167], v[166:167], v[54:55], v[166:167]
    v_pk_fma_f32 v[168:169], v[168:169], v[56:57], v[168:169]
    v_pk_fma_f32 v[170:171], v[170:171], v[58:59], v[170:171]
    v_pk_fma_f32 v[172:173], v[172:173], v[60:61], v[172:173]
    v_pk_fma_f32 v[174:175], v[174:175], v[62:63], v[174:175]
    v_mfma_f32_32x32x16_bf16 v[16:31], a[48:51], a[16:19], v[192:207]
    s_add_u32 s19, s19, 1
    v_exp_f32 v48, v32
    v_exp_f32 v49, v33
    v_exp_f32 v50, v34
    v_mfma_f32_32x32x16_bf16 v[16:31], a[52:55], a[20:23], v[16:31]
    v_exp_f32 v51, v35
    v_exp_f32 v52, v36
    v_exp_f32_e64 v53, v37
    v_mfma_f32_32x32x16_bf16 v[16:31], a[56:59], a[24:27], v[16:31]
    v_exp_f32 v54, v38
    v_exp_f32 v55, v39
    v_exp_f32_e64 v56, v40
    v_mfma_f32_32x32x16_bf16 v[16:31], a[60:63], a[28:31], v[16:31]
    buffer_load_dwordx4 a[4:7], v0, s[4:7], 0 offen offset:16
    v_exp_f32 v57, v41
    v_exp_f32 v58, v42
    v_exp_f32_e64 v59, v43
    v_mfma_f32_32x32x8_bf16 v[16:31], a[176:177], a[250:251], v[16:31]
    v_and_b32 v4, v14, v6
    v_add_u32 v2, 12, v2
    v_exp_f32 v60, v44
    v_exp_f32 v61, v45
    v_exp_f32 v62, v46
    v_exp_f32 v63, v47
    v_pk_fma_f32 v[112:113], v[112:113], v[48:49], v[112:113]
    v_pk_fma_f32 v[114:115], v[114:115], v[50:51], v[114:115]
    v_pk_fma_f32 v[116:117], v[116:117], v[52:53], v[116:117]
    v_pk_fma_f32 v[118:119], v[118:119], v[54:55], v[118:119]
    v_pk_fma_f32 v[120:121], v[120:121], v[56:57], v[120:121]
    v_pk_fma_f32 v[122:123], v[122:123], v[58:59], v[122:123]
    v_pk_fma_f32 v[124:125], v[124:125], v[60:61], v[124:125]
    v_pk_fma_f32 v[126:127], v[126:127], v[62:63], v[126:127]
    v_pk_fma_f32 v[112:113], v[32:33], v[176:177], v[112:113]
    v_pk_fma_f32 v[114:115], v[34:35], v[178:179], v[114:115]
    v_pk_fma_f32 v[116:117], v[36:37], v[180:181], v[116:117]
    v_pk_fma_f32 v[118:119], v[38:39], v[182:183], v[118:119]
    v_pk_fma_f32 v[120:121], v[40:41], v[184:185], v[120:121]
    v_pk_fma_f32 v[122:123], v[42:43], v[186:187], v[122:123]
    v_pk_fma_f32 v[124:125], v[44:45], v[188:189], v[124:125]
    v_pk_fma_f32 v[126:127], v[46:47], v[190:191], v[126:127]
    v_pk_fma_f32 v[176:177], v[176:177], v[48:49], v[176:177]
    v_pk_fma_f32 v[178:179], v[178:179], v[50:51], v[178:179]
    v_pk_fma_f32 v[180:181], v[180:181], v[52:53], v[180:181]
    v_pk_fma_f32 v[182:183], v[182:183], v[54:55], v[182:183]
    v_pk_fma_f32 v[184:185], v[184:185], v[56:57], v[184:185]
    v_pk_fma_f32 v[186:187], v[186:187], v[58:59], v[186:187]
    v_pk_fma_f32 v[188:189], v[188:189], v[60:61], v[188:189]
    v_pk_fma_f32 v[190:191], v[190:191], v[62:63], v[190:191]
K_A0:
    v_mfma_f32_32x32x16_bf16 v[32:47], a[64:67], a[16:19], v[208:223]
    ds_read_b32 v6, v2 offset:20
    v_exp_f32 v48, v16
    v_exp_f32 v49, v17
    v_exp_f32_e64 v50, v18
    v_mfma_f32_32x32x16_bf16 v[32:47], a[68:71], a[20:23], v[32:47]
    v_exp_f32 v51, v19
    v_exp_f32 v52, v20
    v_exp_f32_e64 v53, v21
    v_mfma_f32_32x32x16_bf16 v[32:47], a[72:75], a[24:27], v[32:47]
    v_exp_f32 v54, v22
    v_exp_f32 v55, v23
    v_exp_f32_e64 v56, v24
    v_mfma_f32_32x32x16_bf16 v[32:47], a[76:79], a[28:31], v[32:47]
    buffer_load_dwordx4 a[8:11], v0, s[4:7], 0 offen offset:32
    v_exp_f32 v57, v25
    v_exp_f32 v58, v26
    v_exp_f32_e64 v59, v27
    v_mfma_f32_32x32x8_bf16 v[32:47], a[178:179], a[250:251], v[32:47]
    v_cmpx_lt_u32 vcc, s19, v3
    v_exp_f32 v60, v28
    v_exp_f32 v61, v29
    v_exp_f32 v62, v30
    v_exp_f32_e64 v63, v31
    v_pk_fma_f32 v[64:65], v[64:65], v[48:49], v[64:65]
    v_pk_fma_f32 v[66:67], v[66:67], v[50:51], v[66:67]
    v_pk_fma_f32 v[68:69], v[68:69], v[52:53], v[68:69]
    v_pk_fma_f32 v[70:71], v[70:71], v[54:55], v[70:71]
    v_pk_fma_f32 v[72:73], v[72:73], v[56:57], v[72:73]
    v_pk_fma_f32 v[74:75], v[74:75], v[58:59], v[74:75]
    v_pk_fma_f32 v[76:77], v[76:77], v[60:61], v[76:77]
    v_pk_fma_f32 v[78:79], v[78:79], v[62:63], v[78:79]
    v_pk_fma_f32 v[64:65], v[16:17], v[128:129], v[64:65]
    v_pk_fma_f32 v[66:67], v[18:19], v[130:131], v[66:67]
    v_pk_fma_f32 v[68:69], v[20:21], v[132:133], v[68:69]
    v_pk_fma_f32 v[70:71], v[22:23], v[134:135], v[70:71]
    v_pk_fma_f32 v[72:73], v[24:25], v[136:137], v[72:73]
    v_pk_fma_f32 v[74:75], v[26:27], v[138:139], v[74:75]
    v_pk_fma_f32 v[76:77], v[28:29], v[140:141], v[76:77]
    v_pk_fma_f32 v[78:79], v[30:31], v[142:143], v[78:79]
    v_pk_fma_f32 v[128:129], v[128:129], v[48:49], v[128:129]
    v_pk_fma_f32 v[130:131], v[130:131], v[50:51], v[130:131]
    v_pk_fma_f32 v[132:133], v[132:133], v[52:53], v[132:133]
    v_pk_fma_f32 v[134:135], v[134:135], v[54:55], v[134:135]
    v_pk_fma_f32 v[136:137], v[136:137], v[56:57], v[136:137]
    v_pk_fma_f32 v[138:139], v[138:139], v[58:59], v[138:139]
    v_pk_fma_f32 v[140:141], v[140:141], v[60:61], v[140:141]
    v_pk_fma_f32 v[142:143], v[142:143], v[62:63], v[142:143]
    v_mfma_f32_32x32x16_bf16 v[16:31], a[80:83], a[16:19], v[224:239]
    v_exp_f32 v48, v32
    v_exp_f32 v49, v33
    v_exp_f32_e64 v50, v34
    v_mfma_f32_32x32x16_bf16 v[16:31], a[84:87], a[20:23], v[16:31]
    s_cmp_lt_i32 s19, s37
    v_exp_f32 v51, v35
    v_exp_f32 v52, v36
    v_exp_f32 v53, v37
    v_mfma_f32_32x32x16_bf16 v[16:31], a[88:91], a[24:27], v[16:31]
    s_waitcnt lgkmcnt(0)
    v_exp_f32 v54, v38
    v_exp_f32 v55, v39
    v_exp_f32 v56, v40
    v_mfma_f32_32x32x16_bf16 v[16:31], a[92:95], a[28:31], v[16:31]
    buffer_load_dwordx4 a[12:15], v0, s[4:7], 0 offen offset:48
    v_exp_f32 v57, v41
    v_exp_f32 v58, v42
    v_exp_f32_e64 v59, v43
    v_mfma_f32_32x32x8_bf16 v[16:31], a[180:181], a[250:251], v[16:31]
    v_mad_u32_u16 v0, v6, s59, v1 op_sel:[1,0,0,0]
    v_exp_f32 v60, v44
    v_exp_f32 v61, v45
    v_exp_f32 v62, v46
    v_exp_f32 v63, v47
    v_pk_fma_f32 v[80:81], v[80:81], v[48:49], v[80:81]
    v_pk_fma_f32 v[82:83], v[82:83], v[50:51], v[82:83]
    v_pk_fma_f32 v[84:85], v[84:85], v[52:53], v[84:85]
    v_pk_fma_f32 v[86:87], v[86:87], v[54:55], v[86:87]
    v_pk_fma_f32 v[88:89], v[88:89], v[56:57], v[88:89]
    v_pk_fma_f32 v[90:91], v[90:91], v[58:59], v[90:91]
    v_pk_fma_f32 v[92:93], v[92:93], v[60:61], v[92:93]
    v_pk_fma_f32 v[94:95], v[94:95], v[62:63], v[94:95]
    v_pk_fma_f32 v[80:81], v[32:33], v[144:145], v[80:81]
    v_pk_fma_f32 v[82:83], v[34:35], v[146:147], v[82:83]
    v_pk_fma_f32 v[84:85], v[36:37], v[148:149], v[84:85]
    v_pk_fma_f32 v[86:87], v[38:39], v[150:151], v[86:87]
    v_pk_fma_f32 v[88:89], v[40:41], v[152:153], v[88:89]
    v_pk_fma_f32 v[90:91], v[42:43], v[154:155], v[90:91]
    v_pk_fma_f32 v[92:93], v[44:45], v[156:157], v[92:93]
    v_pk_fma_f32 v[94:95], v[46:47], v[158:159], v[94:95]
    v_pk_fma_f32 v[144:145], v[144:145], v[48:49], v[144:145]
    v_pk_fma_f32 v[146:147], v[146:147], v[50:51], v[146:147]
    v_pk_fma_f32 v[148:149], v[148:149], v[52:53], v[148:149]
    v_pk_fma_f32 v[150:151], v[150:151], v[54:55], v[150:151]
    v_pk_fma_f32 v[152:153], v[152:153], v[56:57], v[152:153]
    v_pk_fma_f32 v[154:155], v[154:155], v[58:59], v[154:155]
    v_pk_fma_f32 v[156:157], v[156:157], v[60:61], v[156:157]
    v_pk_fma_f32 v[158:159], v[158:159], v[62:63], v[158:159]
    v_mfma_f32_32x32x16_bf16 v[32:47], a[96:99], a[16:19], v[240:255]
    s_cselect_b32 s6, s26, 0
    v_exp_f32 v48, v16
    v_exp_f32 v49, v17
    v_exp_f32 v50, v18
    v_mfma_f32_32x32x16_bf16 v[32:47], a[100:103], a[20:23], v[32:47]
    s_cmp_ge_u32 s19, s20
    v_exp_f32 v51, v19
    v_exp_f32 v52, v20
    v_exp_f32 v53, v21
    v_mfma_f32_32x32x16_bf16 v[32:47], a[104:107], a[24:27], v[32:47]
    s_waitcnt vmcnt(4)
    v_exp_f32 v54, v22
    v_exp_f32 v55, v23
    v_exp_f32 v56, v24
    v_mfma_f32_32x32x16_bf16 v[32:47], a[108:111], a[28:31], v[32:47]
    ds_read_b64 a[248:249], v4
    v_exp_f32 v57, v25
    v_exp_f32 v58, v26
    v_exp_f32_e64 v59, v27
    v_mfma_f32_32x32x8_bf16 v[32:47], a[182:183], a[250:251], v[32:47]
    s_cbranch_scc1 K_MID
    buffer_load_dwordx4 a[16:19], v0, s[4:7], 0 offen offset:0
    v_exp_f32 v60, v28
    v_exp_f32 v61, v29
    v_exp_f32 v62, v30
    v_exp_f32_e64 v63, v31
    v_pk_fma_f32 v[96:97], v[96:97], v[48:49], v[96:97]
    v_pk_fma_f32 v[98:99], v[98:99], v[50:51], v[98:99]
    v_pk_fma_f32 v[100:101], v[100:101], v[52:53], v[100:101]
    v_pk_fma_f32 v[102:103], v[102:103], v[54:55], v[102:103]
    v_pk_fma_f32 v[104:105], v[104:105], v[56:57], v[104:105]
    v_pk_fma_f32 v[106:107], v[106:107], v[58:59], v[106:107]
    v_pk_fma_f32 v[108:109], v[108:109], v[60:61], v[108:109]
    v_pk_fma_f32 v[110:111], v[110:111], v[62:63], v[110:111]
    v_pk_fma_f32 v[96:97], v[16:17], v[160:161], v[96:97]
    v_pk_fma_f32 v[98:99], v[18:19], v[162:163], v[98:99]
    v_pk_fma_f32 v[100:101], v[20:21], v[164:165], v[100:101]
    v_pk_fma_f32 v[102:103], v[22:23], v[166:167], v[102:103]
    v_pk_fma_f32 v[104:105], v[24:25], v[168:169], v[104:105]
    v_pk_fma_f32 v[106:107], v[26:27], v[170:171], v[106:107]
    v_pk_fma_f32 v[108:109], v[28:29], v[172:173], v[108:109]
    v_pk_fma_f32 v[110:111], v[30:31], v[174:175], v[110:111]
    v_pk_fma_f32 v[160:161], v[160:161], v[48:49], v[160:161]
    v_pk_fma_f32 v[162:163], v[162:163], v[50:51], v[162:163]
    v_pk_fma_f32 v[164:165], v[164:165], v[52:53], v[164:165]
    v_pk_fma_f32 v[166:167], v[166:167], v[54:55], v[166:167]
    v_pk_fma_f32 v[168:169], v[168:169], v[56:57], v[168:169]
    v_pk_fma_f32 v[170:171], v[170:171], v[58:59], v[170:171]
    v_pk_fma_f32 v[172:173], v[172:173], v[60:61], v[172:173]
    v_pk_fma_f32 v[174:175], v[174:175], v[62:63], v[174:175]
    v_mfma_f32_32x32x16_bf16 v[16:31], a[48:51], a[32:35], v[192:207]
    s_add_u32 s19, s19, 1
    v_exp_f32 v48, v32
    v_exp_f32 v49, v33
    v_exp_f32 v50, v34
    v_mfma_f32_32x32x16_bf16 v[16:31], a[52:55], a[36:39], v[16:31]
    v_exp_f32 v51, v35
    v_exp_f32 v52, v36
    v_exp_f32_e64 v53, v37
    v_mfma_f32_32x32x16_bf16 v[16:31], a[56:59], a[40:43], v[16:31]
    v_exp_f32 v54, v38
    v_exp_f32 v55, v39
    v_exp_f32_e64 v56, v40
    v_mfma_f32_32x32x16_bf16 v[16:31], a[60:63], a[44:47], v[16:31]
    buffer_load_dwordx4 a[20:23], v0, s[4:7], 0 offen offset:16
    v_exp_f32 v57, v41
    v_exp_f32 v58, v42
    v_exp_f32_e64 v59, v43
    v_mfma_f32_32x32x8_bf16 v[16:31], a[176:177], a[252:253], v[16:31]
    v_and_b32 v4, v14, v6
    v_exp_f32 v60, v44
    v_exp_f32 v61, v45
    v_exp_f32 v62, v46
    v_exp_f32_e64 v63, v47
    v_pk_fma_f32 v[112:113], v[112:113], v[48:49], v[112:113]
    v_pk_fma_f32 v[114:115], v[114:115], v[50:51], v[114:115]
    v_pk_fma_f32 v[116:117], v[116:117], v[52:53], v[116:117]
    v_pk_fma_f32 v[118:119], v[118:119], v[54:55], v[118:119]
    v_pk_fma_f32 v[120:121], v[120:121], v[56:57], v[120:121]
    v_pk_fma_f32 v[122:123], v[122:123], v[58:59], v[122:123]
    v_pk_fma_f32 v[124:125], v[124:125], v[60:61], v[124:125]
    v_pk_fma_f32 v[126:127], v[126:127], v[62:63], v[126:127]
    v_pk_fma_f32 v[112:113], v[32:33], v[176:177], v[112:113]
    v_pk_fma_f32 v[114:115], v[34:35], v[178:179], v[114:115]
    v_pk_fma_f32 v[116:117], v[36:37], v[180:181], v[116:117]
    v_pk_fma_f32 v[118:119], v[38:39], v[182:183], v[118:119]
    v_pk_fma_f32 v[120:121], v[40:41], v[184:185], v[120:121]
    v_pk_fma_f32 v[122:123], v[42:43], v[186:187], v[122:123]
    v_pk_fma_f32 v[124:125], v[44:45], v[188:189], v[124:125]
    v_pk_fma_f32 v[126:127], v[46:47], v[190:191], v[126:127]
    v_pk_fma_f32 v[176:177], v[176:177], v[48:49], v[176:177]
    v_pk_fma_f32 v[178:179], v[178:179], v[50:51], v[178:179]
    v_pk_fma_f32 v[180:181], v[180:181], v[52:53], v[180:181]
    v_pk_fma_f32 v[182:183], v[182:183], v[54:55], v[182:183]
    v_pk_fma_f32 v[184:185], v[184:185], v[56:57], v[184:185]
    v_pk_fma_f32 v[186:187], v[186:187], v[58:59], v[186:187]
    v_pk_fma_f32 v[188:189], v[188:189], v[60:61], v[188:189]
    v_pk_fma_f32 v[190:191], v[190:191], v[62:63], v[190:191]
    v_mfma_f32_32x32x16_bf16 v[32:47], a[64:67], a[32:35], v[208:223]
    ds_read_b32 v6, v2 offset:24
    v_exp_f32 v48, v16
    v_exp_f32 v49, v17
    v_exp_f32_e64 v50, v18
    v_mfma_f32_32x32x16_bf16 v[32:47], a[68:71], a[36:39], v[32:47]
    v_exp_f32 v51, v19
    v_exp_f32 v52, v20
    v_exp_f32_e64 v53, v21
    v_mfma_f32_32x32x16_bf16 v[32:47], a[72:75], a[40:43], v[32:47]
    v_exp_f32 v54, v22
    v_exp_f32 v55, v23
    v_exp_f32_e64 v56, v24
    v_mfma_f32_32x32x16_bf16 v[32:47], a[76:79], a[44:47], v[32:47]
    buffer_load_dwordx4 a[24:27], v0, s[4:7], 0 offen offset:32
    v_exp_f32 v57, v25
    v_exp_f32 v58, v26
    v_exp_f32_e64 v59, v27
    v_mfma_f32_32x32x8_bf16 v[32:47], a[178:179], a[252:253], v[32:47]
    v_cmpx_lt_u32 vcc, s19, v3
    v_exp_f32 v60, v28
    v_exp_f32 v61, v29
    v_exp_f32 v62, v30
    v_exp_f32_e64 v63, v31
    v_pk_fma_f32 v[64:65], v[64:65], v[48:49], v[64:65]
    v_pk_fma_f32 v[66:67], v[66:67], v[50:51], v[66:67]
    v_pk_fma_f32 v[68:69], v[68:69], v[52:53], v[68:69]
    v_pk_fma_f32 v[70:71], v[70:71], v[54:55], v[70:71]
    v_pk_fma_f32 v[72:73], v[72:73], v[56:57], v[72:73]
    v_pk_fma_f32 v[74:75], v[74:75], v[58:59], v[74:75]
    v_pk_fma_f32 v[76:77], v[76:77], v[60:61], v[76:77]
    v_pk_fma_f32 v[78:79], v[78:79], v[62:63], v[78:79]
    v_pk_fma_f32 v[64:65], v[16:17], v[128:129], v[64:65]
    v_pk_fma_f32 v[66:67], v[18:19], v[130:131], v[66:67]
    v_pk_fma_f32 v[68:69], v[20:21], v[132:133], v[68:69]
    v_pk_fma_f32 v[70:71], v[22:23], v[134:135], v[70:71]
    v_pk_fma_f32 v[72:73], v[24:25], v[136:137], v[72:73]
    v_pk_fma_f32 v[74:75], v[26:27], v[138:139], v[74:75]
    v_pk_fma_f32 v[76:77], v[28:29], v[140:141], v[76:77]
    v_pk_fma_f32 v[78:79], v[30:31], v[142:143], v[78:79]
    v_pk_fma_f32 v[128:129], v[128:129], v[48:49], v[128:129]
    v_pk_fma_f32 v[130:131], v[130:131], v[50:51], v[130:131]
    v_pk_fma_f32 v[132:133], v[132:133], v[52:53], v[132:133]
    v_pk_fma_f32 v[134:135], v[134:135], v[54:55], v[134:135]
    v_pk_fma_f32 v[136:137], v[136:137], v[56:57], v[136:137]
    v_pk_fma_f32 v[138:139], v[138:139], v[58:59], v[138:139]
    v_pk_fma_f32 v[140:141], v[140:141], v[60:61], v[140:141]
    v_pk_fma_f32 v[142:143], v[142:143], v[62:63], v[142:143]
    v_mfma_f32_32x32x16_bf16 v[16:31], a[80:83], a[32:35], v[224:239]
    v_exp_f32 v48, v32
    v_exp_f32 v49, v33
    v_exp_f32_e64 v50, v34
    v_mfma_f32_32x32x16_bf16 v[16:31], a[84:87], a[36:39], v[16:31]
    s_cmp_lt_i32 s19, s37
    v_exp_f32 v51, v35
    v_exp_f32 v52, v36
    v_exp_f32 v53, v37
    v_mfma_f32_32x32x16_bf16 v[16:31], a[88:91], a[40:43], v[16:31]
    s_waitcnt lgkmcnt(0)
    v_exp_f32 v54, v38
    v_exp_f32 v55, v39
    v_exp_f32 v56, v40
    v_mfma_f32_32x32x16_bf16 v[16:31], a[92:95], a[44:47], v[16:31]
    buffer_load_dwordx4 a[28:31], v0, s[4:7], 0 offen offset:48
    v_exp_f32 v57, v41
    v_exp_f32 v58, v42
    v_exp_f32_e64 v59, v43
    v_mfma_f32_32x32x8_bf16 v[16:31], a[180:181], a[252:253], v[16:31]
    v_mad_u32_u16 v0, v6, s59, v1 op_sel:[1,0,0,0]
    v_exp_f32 v60, v44
    v_exp_f32 v61, v45
    v_exp_f32 v62, v46
    v_exp_f32 v63, v47
    v_pk_fma_f32 v[80:81], v[80:81], v[48:49], v[80:81]
    v_pk_fma_f32 v[82:83], v[82:83], v[50:51], v[82:83]
    v_pk_fma_f32 v[84:85], v[84:85], v[52:53], v[84:85]
    v_pk_fma_f32 v[86:87], v[86:87], v[54:55], v[86:87]
    v_pk_fma_f32 v[88:89], v[88:89], v[56:57], v[88:89]
    v_pk_fma_f32 v[90:91], v[90:91], v[58:59], v[90:91]
    v_pk_fma_f32 v[92:93], v[92:93], v[60:61], v[92:93]
    v_pk_fma_f32 v[94:95], v[94:95], v[62:63], v[94:95]
    v_pk_fma_f32 v[80:81], v[32:33], v[144:145], v[80:81]
    v_pk_fma_f32 v[82:83], v[34:35], v[146:147], v[82:83]
    v_pk_fma_f32 v[84:85], v[36:37], v[148:149], v[84:85]
    v_pk_fma_f32 v[86:87], v[38:39], v[150:151], v[86:87]
    v_pk_fma_f32 v[88:89], v[40:41], v[152:153], v[88:89]
    v_pk_fma_f32 v[90:91], v[42:43], v[154:155], v[90:91]
    v_pk_fma_f32 v[92:93], v[44:45], v[156:157], v[92:93]
    v_pk_fma_f32 v[94:95], v[46:47], v[158:159], v[94:95]
    v_pk_fma_f32 v[144:145], v[144:145], v[48:49], v[144:145]
    v_pk_fma_f32 v[146:147], v[146:147], v[50:51], v[146:147]
    v_pk_fma_f32 v[148:149], v[148:149], v[52:53], v[148:149]
    v_pk_fma_f32 v[150:151], v[150:151], v[54:55], v[150:151]
    v_pk_fma_f32 v[152:153], v[152:153], v[56:57], v[152:153]
    v_pk_fma_f32 v[154:155], v[154:155], v[58:59], v[154:155]
    v_pk_fma_f32 v[156:157], v[156:157], v[60:61], v[156:157]
    v_pk_fma_f32 v[158:159], v[158:159], v[62:63], v[158:159]
    v_mfma_f32_32x32x16_bf16 v[32:47], a[96:99], a[32:35], v[240:255]
    s_cselect_b32 s6, s26, 0
    v_exp_f32 v48, v16
    v_exp_f32 v49, v17
    v_exp_f32 v50, v18
    v_mfma_f32_32x32x16_bf16 v[32:47], a[100:103], a[36:39], v[32:47]
    s_cmp_ge_u32 s19, s20
    v_exp_f32 v51, v19
    v_exp_f32 v52, v20
    v_exp_f32 v53, v21
    v_mfma_f32_32x32x16_bf16 v[32:47], a[104:107], a[40:43], v[32:47]
    s_waitcnt vmcnt(4)
    v_exp_f32 v54, v22
    v_exp_f32 v55, v23
    v_exp_f32 v56, v24
    v_mfma_f32_32x32x16_bf16 v[32:47], a[108:111], a[44:47], v[32:47]
    ds_read_b64 a[250:251], v4
    v_exp_f32 v57, v25
    v_exp_f32 v58, v26
    v_exp_f32_e64 v59, v27
    v_mfma_f32_32x32x8_bf16 v[32:47], a[182:183], a[252:253], v[32:47]
    s_cbranch_scc1 K_MID
    buffer_load_dwordx4 a[32:35], v0, s[4:7], 0 offen offset:0
    v_exp_f32 v60, v28
    v_exp_f32 v61, v29
    v_exp_f32 v62, v30
    v_exp_f32_e64 v63, v31
    v_pk_fma_f32 v[96:97], v[96:97], v[48:49], v[96:97]
    v_pk_fma_f32 v[98:99], v[98:99], v[50:51], v[98:99]
    v_pk_fma_f32 v[100:101], v[100:101], v[52:53], v[100:101]
    v_pk_fma_f32 v[102:103], v[102:103], v[54:55], v[102:103]
    v_pk_fma_f32 v[104:105], v[104:105], v[56:57], v[104:105]
    v_pk_fma_f32 v[106:107], v[106:107], v[58:59], v[106:107]
    v_pk_fma_f32 v[108:109], v[108:109], v[60:61], v[108:109]
    v_pk_fma_f32 v[110:111], v[110:111], v[62:63], v[110:111]
    v_pk_fma_f32 v[96:97], v[16:17], v[160:161], v[96:97]
    v_pk_fma_f32 v[98:99], v[18:19], v[162:163], v[98:99]
    v_pk_fma_f32 v[100:101], v[20:21], v[164:165], v[100:101]
    v_pk_fma_f32 v[102:103], v[22:23], v[166:167], v[102:103]
    v_pk_fma_f32 v[104:105], v[24:25], v[168:169], v[104:105]
    v_pk_fma_f32 v[106:107], v[26:27], v[170:171], v[106:107]
    v_pk_fma_f32 v[108:109], v[28:29], v[172:173], v[108:109]
    v_pk_fma_f32 v[110:111], v[30:31], v[174:175], v[110:111]
    v_pk_fma_f32 v[160:161], v[160:161], v[48:49], v[160:161]
    v_pk_fma_f32 v[162:163], v[162:163], v[50:51], v[162:163]
    v_pk_fma_f32 v[164:165], v[164:165], v[52:53], v[164:165]
    v_pk_fma_f32 v[166:167], v[166:167], v[54:55], v[166:167]
    v_pk_fma_f32 v[168:169], v[168:169], v[56:57], v[168:169]
    v_pk_fma_f32 v[170:171], v[170:171], v[58:59], v[170:171]
    v_pk_fma_f32 v[172:173], v[172:173], v[60:61], v[172:173]
    v_pk_fma_f32 v[174:175], v[174:175], v[62:63], v[174:175]
    v_mfma_f32_32x32x16_bf16 v[16:31], a[48:51], a[0:3], v[192:207]
    s_add_u32 s19, s19, 1
    v_exp_f32 v48, v32
    v_exp_f32 v49, v33
    v_exp_f32 v50, v34
    v_mfma_f32_32x32x16_bf16 v[16:31], a[52:55], a[4:7], v[16:31]
    v_exp_f32 v51, v35
    v_exp_f32 v52, v36
    v_exp_f32_e64 v53, v37
    v_mfma_f32_32x32x16_bf16 v[16:31], a[56:59], a[8:11], v[16:31]
    v_exp_f32 v54, v38
    v_exp_f32 v55, v39
    v_exp_f32_e64 v56, v40
    v_mfma_f32_32x32x16_bf16 v[16:31], a[60:63], a[12:15], v[16:31]
    buffer_load_dwordx4 a[36:39], v0, s[4:7], 0 offen offset:16
    v_exp_f32 v57, v41
    v_exp_f32 v58, v42
    v_exp_f32_e64 v59, v43
    v_mfma_f32_32x32x8_bf16 v[16:31], a[176:177], a[248:249], v[16:31]
    v_and_b32 v4, v14, v6
    v_exp_f32 v60, v44
    v_exp_f32 v61, v45
    v_exp_f32 v62, v46
    v_exp_f32_e64 v63, v47
    v_pk_fma_f32 v[112:113], v[112:113], v[48:49], v[112:113]
    v_pk_fma_f32 v[114:115], v[114:115], v[50:51], v[114:115]
    v_pk_fma_f32 v[116:117], v[116:117], v[52:53], v[116:117]
    v_pk_fma_f32 v[118:119], v[118:119], v[54:55], v[118:119]
    v_pk_fma_f32 v[120:121], v[120:121], v[56:57], v[120:121]
    v_pk_fma_f32 v[122:123], v[122:123], v[58:59], v[122:123]
    v_pk_fma_f32 v[124:125], v[124:125], v[60:61], v[124:125]
    v_pk_fma_f32 v[126:127], v[126:127], v[62:63], v[126:127]
    v_pk_fma_f32 v[112:113], v[32:33], v[176:177], v[112:113]
    v_pk_fma_f32 v[114:115], v[34:35], v[178:179], v[114:115]
    v_pk_fma_f32 v[116:117], v[36:37], v[180:181], v[116:117]
    v_pk_fma_f32 v[118:119], v[38:39], v[182:183], v[118:119]
    v_pk_fma_f32 v[120:121], v[40:41], v[184:185], v[120:121]
    v_pk_fma_f32 v[122:123], v[42:43], v[186:187], v[122:123]
    v_pk_fma_f32 v[124:125], v[44:45], v[188:189], v[124:125]
    v_pk_fma_f32 v[126:127], v[46:47], v[190:191], v[126:127]
    v_pk_fma_f32 v[176:177], v[176:177], v[48:49], v[176:177]
    v_pk_fma_f32 v[178:179], v[178:179], v[50:51], v[178:179]
    v_pk_fma_f32 v[180:181], v[180:181], v[52:53], v[180:181]
    v_pk_fma_f32 v[182:183], v[182:183], v[54:55], v[182:183]
    v_pk_fma_f32 v[184:185], v[184:185], v[56:57], v[184:185]
    v_pk_fma_f32 v[186:187], v[186:187], v[58:59], v[186:187]
    v_pk_fma_f32 v[188:189], v[188:189], v[60:61], v[188:189]
    v_pk_fma_f32 v[190:191], v[190:191], v[62:63], v[190:191]
    v_mfma_f32_32x32x16_bf16 v[32:47], a[64:67], a[0:3], v[208:223]
    ds_read_b32 v6, v2 offset:28
    v_exp_f32 v48, v16
    v_exp_f32 v49, v17
    v_exp_f32_e64 v50, v18
    v_mfma_f32_32x32x16_bf16 v[32:47], a[68:71], a[4:7], v[32:47]
    v_exp_f32 v51, v19
    v_exp_f32 v52, v20
    v_exp_f32_e64 v53, v21
    v_mfma_f32_32x32x16_bf16 v[32:47], a[72:75], a[8:11], v[32:47]
    v_exp_f32 v54, v22
    v_exp_f32 v55, v23
    v_exp_f32_e64 v56, v24
    v_mfma_f32_32x32x16_bf16 v[32:47], a[76:79], a[12:15], v[32:47]
    buffer_load_dwordx4 a[40:43], v0, s[4:7], 0 offen offset:32
    v_exp_f32 v57, v25
    v_exp_f32 v58, v26
    v_exp_f32_e64 v59, v27
    v_mfma_f32_32x32x8_bf16 v[32:47], a[178:179], a[248:249], v[32:47]
    v_cmpx_lt_u32 vcc, s19, v3
    v_exp_f32 v60, v28
    v_exp_f32 v61, v29
    v_exp_f32 v62, v30
    v_exp_f32_e64 v63, v31
    v_pk_fma_f32 v[64:65], v[64:65], v[48:49], v[64:65]
    v_pk_fma_f32 v[66:67], v[66:67], v[50:51], v[66:67]
    v_pk_fma_f32 v[68:69], v[68:69], v[52:53], v[68:69]
    v_pk_fma_f32 v[70:71], v[70:71], v[54:55], v[70:71]
    v_pk_fma_f32 v[72:73], v[72:73], v[56:57], v[72:73]
    v_pk_fma_f32 v[74:75], v[74:75], v[58:59], v[74:75]
    v_pk_fma_f32 v[76:77], v[76:77], v[60:61], v[76:77]
    v_pk_fma_f32 v[78:79], v[78:79], v[62:63], v[78:79]
    v_pk_fma_f32 v[64:65], v[16:17], v[128:129], v[64:65]
    v_pk_fma_f32 v[66:67], v[18:19], v[130:131], v[66:67]
    v_pk_fma_f32 v[68:69], v[20:21], v[132:133], v[68:69]
    v_pk_fma_f32 v[70:71], v[22:23], v[134:135], v[70:71]
    v_pk_fma_f32 v[72:73], v[24:25], v[136:137], v[72:73]
    v_pk_fma_f32 v[74:75], v[26:27], v[138:139], v[74:75]
    v_pk_fma_f32 v[76:77], v[28:29], v[140:141], v[76:77]
    v_pk_fma_f32 v[78:79], v[30:31], v[142:143], v[78:79]
    v_pk_fma_f32 v[128:129], v[128:129], v[48:49], v[128:129]
    v_pk_fma_f32 v[130:131], v[130:131], v[50:51], v[130:131]
    v_pk_fma_f32 v[132:133], v[132:133], v[52:53], v[132:133]
    v_pk_fma_f32 v[134:135], v[134:135], v[54:55], v[134:135]
    v_pk_fma_f32 v[136:137], v[136:137], v[56:57], v[136:137]
    v_pk_fma_f32 v[138:139], v[138:139], v[58:59], v[138:139]
    v_pk_fma_f32 v[140:141], v[140:141], v[60:61], v[140:141]
    v_pk_fma_f32 v[142:143], v[142:143], v[62:63], v[142:143]
    v_mfma_f32_32x32x16_bf16 v[16:31], a[80:83], a[0:3], v[224:239]
    v_exp_f32 v48, v32
    v_exp_f32 v49, v33
    v_exp_f32_e64 v50, v34
    v_mfma_f32_32x32x16_bf16 v[16:31], a[84:87], a[4:7], v[16:31]
    s_cmp_lt_i32 s19, s37
    v_exp_f32 v51, v35
    v_exp_f32 v52, v36
    v_exp_f32 v53, v37
    v_mfma_f32_32x32x16_bf16 v[16:31], a[88:91], a[8:11], v[16:31]
    s_waitcnt lgkmcnt(0)
    v_exp_f32 v54, v38
    v_exp_f32 v55, v39
    v_exp_f32 v56, v40
    v_mfma_f32_32x32x16_bf16 v[16:31], a[92:95], a[12:15], v[16:31]
    buffer_load_dwordx4 a[44:47], v0, s[4:7], 0 offen offset:48
    v_exp_f32 v57, v41
    v_exp_f32 v58, v42
    v_exp_f32_e64 v59, v43
    v_mfma_f32_32x32x8_bf16 v[16:31], a[180:181], a[248:249], v[16:31]
    v_mad_u32_u16 v0, v6, s59, v1 op_sel:[1,0,0,0]
    v_exp_f32 v60, v44
    v_exp_f32 v61, v45
    v_exp_f32 v62, v46
    v_exp_f32 v63, v47
    v_pk_fma_f32 v[80:81], v[80:81], v[48:49], v[80:81]
    v_pk_fma_f32 v[82:83], v[82:83], v[50:51], v[82:83]
    v_pk_fma_f32 v[84:85], v[84:85], v[52:53], v[84:85]
    v_pk_fma_f32 v[86:87], v[86:87], v[54:55], v[86:87]
    v_pk_fma_f32 v[88:89], v[88:89], v[56:57], v[88:89]
    v_pk_fma_f32 v[90:91], v[90:91], v[58:59], v[90:91]
    v_pk_fma_f32 v[92:93], v[92:93], v[60:61], v[92:93]
    v_pk_fma_f32 v[94:95], v[94:95], v[62:63], v[94:95]
    v_pk_fma_f32 v[80:81], v[32:33], v[144:145], v[80:81]
    v_pk_fma_f32 v[82:83], v[34:35], v[146:147], v[82:83]
    v_pk_fma_f32 v[84:85], v[36:37], v[148:149], v[84:85]
    v_pk_fma_f32 v[86:87], v[38:39], v[150:151], v[86:87]
    v_pk_fma_f32 v[88:89], v[40:41], v[152:153], v[88:89]
    v_pk_fma_f32 v[90:91], v[42:43], v[154:155], v[90:91]
    v_pk_fma_f32 v[92:93], v[44:45], v[156:157], v[92:93]
    v_pk_fma_f32 v[94:95], v[46:47], v[158:159], v[94:95]
    v_pk_fma_f32 v[144:145], v[144:145], v[48:49], v[144:145]
    v_pk_fma_f32 v[146:147], v[146:147], v[50:51], v[146:147]
    v_pk_fma_f32 v[148:149], v[148:149], v[52:53], v[148:149]
    v_pk_fma_f32 v[150:151], v[150:151], v[54:55], v[150:151]
    v_pk_fma_f32 v[152:153], v[152:153], v[56:57], v[152:153]
    v_pk_fma_f32 v[154:155], v[154:155], v[58:59], v[154:155]
    v_pk_fma_f32 v[156:157], v[156:157], v[60:61], v[156:157]
    v_pk_fma_f32 v[158:159], v[158:159], v[62:63], v[158:159]
    v_mfma_f32_32x32x16_bf16 v[32:47], a[96:99], a[0:3], v[240:255]
    s_cselect_b32 s6, s26, 0
    v_exp_f32 v48, v16
    v_exp_f32 v49, v17
    v_exp_f32 v50, v18
    v_mfma_f32_32x32x16_bf16 v[32:47], a[100:103], a[4:7], v[32:47]
    s_cmp_ge_u32 s19, s20
    v_exp_f32 v51, v19
    v_exp_f32 v52, v20
    v_exp_f32 v53, v21
    v_mfma_f32_32x32x16_bf16 v[32:47], a[104:107], a[8:11], v[32:47]
    s_waitcnt vmcnt(4)
    v_exp_f32 v54, v22
    v_exp_f32 v55, v23
    v_exp_f32 v56, v24
    v_mfma_f32_32x32x16_bf16 v[32:47], a[108:111], a[12:15], v[32:47]
    ds_read_b64 a[252:253], v4
    v_exp_f32 v57, v25
    v_exp_f32 v58, v26
    v_exp_f32_e64 v59, v27
    v_mfma_f32_32x32x8_bf16 v[32:47], a[182:183], a[248:249], v[32:47]
    s_cbranch_scc0 K_LOOP0
    s_branch K_MID
K_EXIT0:
.p2align 12
PG4:
    s_branch K_WARM_RET2
    s_nop 0
K_MID:
    v_exp_f32 v60, v28
    v_exp_f32 v61, v29
    v_exp_f32 v62, v30
    v_exp_f32 v63, v31
    v_pk_fma_f32 v[96:97], v[96:97], v[48:49], v[96:97]
    v_pk_fma_f32 v[98:99], v[98:99], v[50:51], v[98:99]
    v_pk_fma_f32 v[100:101], v[100:101], v[52:53], v[100:101]
    v_pk_fma_f32 v[102:103], v[102:103], v[54:55], v[102:103]
    v_pk_fma_f32 v[104:105], v[104:105], v[56:57], v[104:105]
    v_pk_fma_f32 v[106:107], v[106:107], v[58:59], v[106:107]
    v_pk_fma_f32 v[108:109], v[108:109], v[60:61], v[108:109]
    v_pk_fma_f32 v[110:111], v[110:111], v[62:63], v[110:111]
    v_pk_fma_f32 v[96:97], v[16:17], v[160:161], v[96:97]
    v_pk_fma_f32 v[98:99], v[18:19], v[162:163], v[98:99]
    v_pk_fma_f32 v[100:101], v[20:21], v[164:165], v[100:101]
    v_pk_fma_f32 v[102:103], v[22:23], v[166:167], v[102:103]
    v_pk_fma_f32 v[104:105], v[24:25], v[168:169], v[104:105]
    v_pk_fma_f32 v[106:107], v[26:27], v[170:171], v[106:107]
    v_pk_fma_f32 v[108:109], v[28:29], v[172:173], v[108:109]
    v_pk_fma_f32 v[110:111], v[30:31], v[174:175], v[110:111]
    v_pk_fma_f32 v[160:161], v[160:161], v[48:49], v[160:161]
    v_pk_fma_f32 v[162:163], v[162:163], v[50:51], v[162:163]
    v_pk_fma_f32 v[164:165], v[164:165], v[52:53], v[164:165]
    v_pk_fma_f32 v[166:167], v[166:167], v[54:55], v[166:167]
    v_pk_fma_f32 v[168:169], v[168:169], v[56:57], v[168:169]
    v_pk_fma_f32 v[170:171], v[170:171], v[58:59], v[170:171]
    v_pk_fma_f32 v[172:173], v[172:173], v[60:61], v[172:173]
    v_pk_fma_f32 v[174:175], v[174:175], v[62:63], v[174:175]
    s_mov_b64 s[60:61], exec
    s_mov_b64 exec, -1
    v_exp_f32 v48, v32
    v_exp_f32 v49, v33
    v_exp_f32 v50, v34
    v_exp_f32 v51, v35
    v_exp_f32 v52, v36
    v_exp_f32 v53, v37
    v_exp_f32 v54, v38
    v_exp_f32 v55, v39
    v_exp_f32 v56, v40
    v_exp_f32 v57, v41
    v_exp_f32 v58, v42
    v_exp_f32 v59, v43
    v_exp_f32 v60, v44
    v_exp_f32 v61, v45
    v_exp_f32 v62, v46
    v_exp_f32 v63, v47
    v_xor_b32 v4, 16, v9
    v_xor_b32 v6, 32, v9
    v_xor_b32 v2, 48, v9
    s_mov_b32 s6, s26
    v_mad_u32_u16 v0, v10, s59, v1 op_sel:[1,0,0,0]
    s_waitcnt vmcnt(0)
    s_mov_b32 s19, 1
    ds_read_b128 a[32:35], v9
    ds_read_b128 a[36:39], v4
    ds_read_b128 a[40:43], v6
    ds_read_b128 a[44:47], v2
    buffer_load_dwordx4 a[0:3], v0, s[4:7], 0 offen offset:0
    buffer_load_dwordx4 a[4:7], v0, s[4:7], 0 offen offset:16
    buffer_load_dwordx4 a[8:11], v0, s[4:7], 0 offen offset:32
    buffer_load_dwordx4 a[12:15], v0, s[4:7], 0 offen offset:48
    s_mov_b64 exec, s[60:61]
    s_nop 0
    v_pk_fma_f32 v[112:113], v[112:113], v[48:49], v[112:113]
    v_pk_fma_f32 v[114:115], v[114:115], v[50:51], v[114:115]
    v_pk_fma_f32 v[116:117], v[116:117], v[52:53], v[116:117]
    v_pk_fma_f32 v[118:119], v[118:119], v[54:55], v[118:119]
    v_pk_fma_f32 v[120:121], v[120:121], v[56:57], v[120:121]
    v_pk_fma_f32 v[122:123], v[122:123], v[58:59], v[122:123]
    v_pk_fma_f32 v[124:125], v[124:125], v[60:61], v[124:125]
    v_pk_fma_f32 v[126:127], v[126:127], v[62:63], v[126:127]
    v_pk_fma_f32 v[112:113], v[32:33], v[176:177], v[112:113]
    v_pk_fma_f32 v[114:115], v[34:35], v[178:179], v[114:115]
    v_pk_fma_f32 v[116:117], v[36:37], v[180:181], v[116:117]
    v_pk_fma_f32 v[118:119], v[38:39], v[182:183], v[118:119]
    v_pk_fma_f32 v[120:121], v[40:41], v[184:185], v[120:121]
    v_pk_fma_f32 v[122:123], v[42:43], v[186:187], v[122:123]
    v_pk_fma_f32 v[124:125], v[44:45], v[188:189], v[124:125]
    v_pk_fma_f32 v[126:127], v[46:47], v[190:191], v[126:127]
    v_pk_fma_f32 v[176:177], v[176:177], v[48:49], v[176:177]
    v_pk_fma_f32 v[178:179], v[178:179], v[50:51], v[178:179]
    v_pk_fma_f32 v[180:181], v[180:181], v[52:53], v[180:181]
    v_pk_fma_f32 v[182:183], v[182:183], v[54:55], v[182:183]
    v_pk_fma_f32 v[184:185], v[184:185], v[56:57], v[184:185]
    v_pk_fma_f32 v[186:187], v[186:187], v[58:59], v[186:187]
    v_pk_fma_f32 v[188:189], v[188:189], v[60:61], v[188:189]
    v_pk_fma_f32 v[190:191], v[190:191], v[62:63], v[190:191]
    s_mov_b64 exec, -1
    s_waitcnt lgkmcnt(0)
    v_mfma_f32_32x32x16_bf16 v[192:207], a[112:115], a[32:35], 0
    v_mad_u32_u16 v0, v11, s59, v1 op_sel:[1,0,0,0]
    v_bfe_u32 v3, v7, 16, 8
    v_cvt_f32_ubyte2 v50, v5
    v_mov_b32 v49, 0
    v_mov_b32 v51, 0
    v_lshrrev_b32 v48, 16, v50
    v_mfma_f32_32x32x16_bf16 v[192:207], a[116:119], a[36:39], v[192:207]
    buffer_load_dwordx4 a[16:19], v0, s[4:7], 0 offen offset:0
    buffer_load_dwordx4 a[20:23], v0, s[4:7], 0 offen offset:16
    v_readfirstlane_b32 s20, v3
    v_rcp_f32 v128, v128
    v_rcp_f32_e64 v129, v129
    v_mfma_f32_32x32x16_bf16 v[192:207], a[120:123], a[40:43], v[192:207]
    buffer_load_dwordx4 a[24:27], v0, s[4:7], 0 offen offset:32
    v_rcp_f32 v130, v130
    v_rcp_f32 v131, v131
    v_rcp_f32_e64 v132, v132
    v_mfma_f32_32x32x16_bf16 v[192:207], a[124:127], a[44:47], v[192:207]
    buffer_load_dwordx4 a[28:31], v0, s[4:7], 0 offen offset:48
    v_rcp_f32 v133, v133
    v_rcp_f32 v134, v134
    v_rcp_f32_e64 v135, v135
    v_mfma_f32_32x32x16_bf16 v[208:223], a[128:131], a[32:35], 0
    v_rcp_f32 v136, v136
    v_rcp_f32 v137, v137
    v_rcp_f32_e64 v138, v138
    v_mfma_f32_32x32x8_bf16 v[16:31], a[254:255], v[48:49], 0
    v_rcp_f32 v139, v139
    v_rcp_f32 v140, v140
    v_rcp_f32 v141, v141
    v_rcp_f32 v142, v142
    v_mfma_f32_32x32x8_bf16 v[32:47], a[254:255], v[50:51], 0
    v_rcp_f32_e64 v143, v143
    v_min3_f32 v52, v128, v129, 1.0
    v_min3_f32 v52, v130, v131, v52
    v_min3_f32 v52, v132, v133, v52
    v_min3_f32 v52, v134, v135, v52
    v_min3_f32 v52, v136, v137, v52
    v_min3_f32 v52, v138, v139, v52
    v_min3_f32 v52, v140, v141, v52
    v_min3_f32 v52, v142, v143, v52
    v_pk_mul_f32 v[64:65], v[64:65], v[128:129]
    v_pk_mul_f32 v[66:67], v[66:67], v[130:131]
    v_pk_mul_f32 v[68:69], v[68:69], v[132:133]
    v_pk_mul_f32 v[70:71], v[70:71], v[134:135]
    v_pk_mul_f32 v[72:73], v[72:73], v[136:137]
    v_pk_mul_f32 v[74:75], v[74:75], v[138:139]
    v_pk_mul_f32 v[76:77], v[76:77], v[140:141]
    v_pk_mul_f32 v[78:79], v[78:79], v[142:143]
    v_mfma_f32_32x32x16_bf16 v[208:223], a[132:135], a[36:39], v[208:223]
    v_cvt_pk_bf16_f32 v64, v64, v65
    v_cvt_pk_bf16_f32 v65, v66, v67
    v_cvt_pk_bf16_f32 v66, v68, v69
    v_cvt_pk_bf16_f32 v67, v70, v71
    v_cvt_pk_bf16_f32 v68, v72, v73
    v_cvt_pk_bf16_f32 v69, v74, v75
    v_mfma_f32_32x32x16_bf16 v[208:223], a[136:139], a[40:43], v[208:223]
    v_cvt_pk_bf16_f32 v70, v76, v77
    v_cvt_pk_bf16_f32 v71, v78, v79
    v_and_b32 v4, v14, v10
    v_and_b32 v6, v14, v11
    v_and_b32 v0, v14, v12
    v_mov_b32 v2, v8
    v_mfma_f32_32x32x16_bf16 v[208:223], a[140:143], a[44:47], v[208:223]
    s_max_u32 s20, s20, 2
    v_rcp_f32 v144, v144
    v_rcp_f32 v145, v145
    v_rcp_f32 v146, v146
    v_mfma_f32_32x32x16_bf16 v[224:239], a[144:147], a[32:35], 0
    s_sub_u32 s37, s20, 3
    v_rcp_f32 v147, v147
    v_rcp_f32 v148, v148
    v_rcp_f32 v149, v149
    v_mfma_f32_32x32x16_bf16 v[16:31], a[184:187], v[64:67], v[16:31]
    ds_read_b64 a[248:249], v4
    ds_read_b64 a[250:251], v6
    ds_read_b64 a[252:253], v0
    v_rcp_f32 v150, v150
    v_rcp_f32 v151, v151
    v_mfma_f32_32x32x16_bf16 v[32:47], a[188:191], v[64:67], v[32:47]
    s_sub_u32 s20, s20, 1
    v_rcp_f32 v152, v152
    v_rcp_f32 v153, v153
    v_rcp_f32 v154, v154
    v_mfma_f32_32x32x16_bf16 v[16:31], a[192:195], v[68:71], v[16:31]
    v_rcp_f32 v155, v155
    v_rcp_f32 v156, v156
    v_rcp_f32_e64 v157, v157
    v_mfma_f32_32x32x16_bf16 v[32:47], a[196:199], v[68:71], v[32:47]
    v_rcp_f32 v158, v158
    v_rcp_f32 v159, v159
    v_min3_f32 v52, v144, v145, v52
    v_min3_f32 v52, v146, v147, v52
    v_min3_f32 v52, v148, v149, v52
    v_min3_f32 v52, v150, v151, v52
    v_min3_f32 v52, v152, v153, v52
    v_min3_f32 v52, v154, v155, v52
    v_min3_f32 v52, v156, v157, v52
    v_min3_f32 v52, v158, v159, v52
    v_pk_mul_f32 v[80:81], v[80:81], v[144:145]
    v_pk_mul_f32 v[82:83], v[82:83], v[146:147]
    v_pk_mul_f32 v[84:85], v[84:85], v[148:149]
    v_pk_mul_f32 v[86:87], v[86:87], v[150:151]
    v_pk_mul_f32 v[88:89], v[88:89], v[152:153]
    v_pk_mul_f32 v[90:91], v[90:91], v[154:155]
    v_pk_mul_f32 v[92:93], v[92:93], v[156:157]
    v_pk_mul_f32 v[94:95], v[94:95], v[158:159]
    v_mfma_f32_32x32x16_bf16 v[224:239], a[148:151], a[36:39], v[224:239]
    v_cvt_pk_bf16_f32 v80, v80, v81
    v_cvt_pk_bf16_f32 v81, v82, v83
    v_cvt_pk_bf16_f32 v82, v84, v85
    v_cvt_pk_bf16_f32 v83, v86, v87
    v_cvt_pk_bf16_f32 v84, v88, v89
    v_cvt_pk_bf16_f32 v85, v90, v91
    v_mfma_f32_32x32x16_bf16 v[224:239], a[152:155], a[40:43], v[224:239]
    v_cvt_pk_bf16_f32 v86, v92, v93
    v_cvt_pk_bf16_f32 v87, v94, v95
    v_rcp_f32 v160, v160
    v_rcp_f32 v161, v161
    v_mfma_f32_32x32x16_bf16 v[224:239], a[156:159], a[44:47], v[224:239]
    v_rcp_f32 v162, v162
    v_rcp_f32 v163, v163
    v_rcp_f32_e64 v164, v164
    v_mfma_f32_32x32x16_bf16 v[16:31], a[200:203], v[80:83], v[16:31]
    v_rcp_f32 v165, v165
    v_rcp_f32 v166, v166
    v_rcp_f32_e64 v167, v167
    v_mfma_f32_32x32x16_bf16 v[32:47], a[204:207], v[80:83], v[32:47]
    v_rcp_f32 v168, v168
    v_rcp_f32 v169, v169
    v_rcp_f32_e64 v170, v170
    v_mfma_f32_32x32x16_bf16 v[16:31], a[208:211], v[84:87], v[16:31]
    s_waitcnt vmcnt(4) lgkmcnt(0)
    v_rcp_f32 v171, v171
    v_rcp_f32 v172, v172
    v_rcp_f32 v173, v173
    v_mfma_f32_32x32x16_bf16 v[32:47], a[212:215], v[84:87], v[32:47]
    v_rcp_f32 v174, v174
    v_rcp_f32 v175, v175
    v_min3_f32 v52, v160, v161, v52
    v_min3_f32 v52, v162, v163, v52
    v_min3_f32 v52, v164, v165, v52
    v_min3_f32 v52, v166, v167, v52
    v_min3_f32 v52, v168, v169, v52
    v_min3_f32 v52, v170, v171, v52
    v_min3_f32 v52, v172, v173, v52
    v_min3_f32 v52, v174, v175, v52
    v_pk_mul_f32 v[96:97], v[96:97], v[160:161]
    v_pk_mul_f32 v[98:99], v[98:99], v[162:163]
    v_pk_mul_f32 v[100:101], v[100:101], v[164:165]
    v_pk_mul_f32 v[102:103], v[102:103], v[166:167]
    v_pk_mul_f32 v[104:105], v[104:105], v[168:169]
    v_pk_mul_f32 v[106:107], v[106:107], v[170:171]
    v_pk_mul_f32 v[108:109], v[108:109], v[172:173]
    v_pk_mul_f32 v[110:111], v[110:111], v[174:175]
    v_mfma_f32_32x32x16_bf16 v[64:79], a[48:51], a[0:3], v[192:207]
    v_cvt_pk_bf16_f32 v96, v96, v97
    v_cvt_pk_bf16_f32 v97, v98, v99
    v_cvt_pk_bf16_f32 v98, v100, v101
    v_cvt_pk_bf16_f32 v99, v102, v103
    v_cvt_pk_bf16_f32 v100, v104, v105
    v_cvt_pk_bf16_f32 v101, v106, v107
    v_mfma_f32_32x32x16_bf16 v[64:79], a[52:55], a[4:7], v[64:79]
    v_cvt_pk_bf16_f32 v102, v108, v109
    v_cvt_pk_bf16_f32 v103, v110, v111
    v_mbcnt_lo_u32_b32 v11, -1, 0
    v_mbcnt_hi_u32_b32 v11, -1, v11
    v_and_or_b32 v8, v11, 31, s45
    v_lshrrev_b32_e64 v9, 3, v11
    v_mfma_f32_32x32x16_bf16 v[64:79], a[56:59], a[8:11], v[64:79]
    v_mad_u32_u24 v8, v8, s55, v1
    v_mul_u32_u24 v9, s47, v9
    v_and_b32 v11, 7, v11
    v_add_u32 v9, s46, v9
    v_lshlrev_b32 v11, 4, v11
    v_add_u32_e64 v10, v9, v11
    v_mfma_f32_32x32x16_bf16 v[64:79], a[60:63], a[12:15], v[64:79]
    v_rcp_f32 v176, v176
    v_rcp_f32 v177, v177
    v_rcp_f32_e64 v178, v178
    v_mfma_f32_32x32x16_bf16 v[16:31], a[216:219], v[96:99], v[16:31]
    v_rcp_f32 v179, v179
    v_rcp_f32 v180, v180
    v_rcp_f32_e64 v181, v181
    v_mfma_f32_32x32x16_bf16 v[32:47], a[220:223], v[96:99], v[32:47]
    v_rcp_f32 v182, v182
    v_rcp_f32 v183, v183
    v_rcp_f32_e64 v184, v184
    v_mfma_f32_32x32x16_bf16 v[16:31], a[224:227], v[100:103], v[16:31]
    v_rcp_f32 v185, v185
    v_rcp_f32 v186, v186
    v_rcp_f32_e64 v187, v187
    v_mfma_f32_32x32x16_bf16 v[32:47], a[228:231], v[100:103], v[32:47]
    v_rcp_f32 v188, v188
    v_rcp_f32 v189, v189
    v_rcp_f32_e64 v190, v190
    v_mfma_f32_32x32x8_bf16 v[64:79], a[176:177], a[248:249], v[64:79]
    v_rcp_f32_e64 v191, v191
    v_min3_f32 v52, v176, v177, v52
    v_min3_f32 v52, v178, v179, v52
    v_min3_f32 v52, v180, v181, v52
    v_min3_f32 v52, v182, v183, v52
    v_min3_f32 v52, v184, v185, v52
    v_min3_f32 v52, v186, v187, v52
    v_min3_f32 v52, v188, v189, v52
    v_min3_f32 v52, v190, v191, v52
    v_pk_mul_f32 v[112:113], v[112:113], v[176:177]
    v_pk_mul_f32 v[114:115], v[114:115], v[178:179]
    v_pk_mul_f32 v[116:117], v[116:117], v[180:181]
    v_pk_mul_f32 v[118:119], v[118:119], v[182:183]
    v_pk_mul_f32 v[120:121], v[120:121], v[184:185]
    v_pk_mul_f32 v[122:123], v[122:123], v[186:187]
    v_pk_mul_f32 v[124:125], v[124:125], v[188:189]
    v_pk_mul_f32 v[126:127], v[126:127], v[190:191]
    v_mfma_f32_32x32x16_bf16 v[80:95], a[64:67], a[0:3], v[208:223]
    v_cvt_pk_bf16_f32 v112, v112, v113
    v_cvt_pk_bf16_f32 v113, v114, v115
    v_cvt_pk_bf16_f32 v114, v116, v117
    v_cvt_pk_bf16_f32 v115, v118, v119
    v_cvt_pk_bf16_f32 v116, v120, v121
    v_cvt_pk_bf16_f32 v117, v122, v123
    v_mfma_f32_32x32x16_bf16 v[80:95], a[68:71], a[4:7], v[80:95]
    v_cvt_pk_bf16_f32 v118, v124, v125
    v_cvt_pk_bf16_f32 v119, v126, v127
    v_lshrrev_b32_e64 v53, 24, v5
    v_and_b32 v55, s54, v5
    v_cmp_eq_u32 vcc, s54, v53
    v_mad_u32_u24 v53, v53, s55, v1
    v_mfma_f32_32x32x16_bf16 v[16:31], a[232:235], v[112:115], v[16:31]
    v_add_lshl_u32 v55, s16, v55, 7
    v_cndmask_b32 v53, v53, v8, vcc
    v_cndmask_b32 v55, 2.0, v55, vcc
    v_cmp_eq_u32 s[38:39], 0, v50
    v_mad_u32_u16 v0, v12, s59, v1 op_sel:[1,0,0,0]
    v_and_b32_e64 v4, v14, v13
    v_mfma_f32_32x32x16_bf16 v[32:47], a[236:239], v[112:115], v[32:47]
    v_mov_b32 v5, v7
    v_cmp_nlt_f32 vcc, s57, v52
    v_exp_f32 v128, v64
    v_exp_f32 v129, v65
    v_mfma_f32_32x32x16_bf16 v[16:31], a[240:243], v[116:119], v[16:31]
    v_exp_f32 v130, v66
    v_exp_f32 v131, v67
    v_exp_f32_e64 v132, v68
    v_mfma_f32_32x32x16_bf16 v[32:47], a[244:247], v[116:119], v[32:47]
    v_exp_f32 v133, v69
    v_exp_f32 v134, v70
    v_exp_f32_e64 v135, v71
    v_mfma_f32_32x32x16_bf16 v[80:95], a[72:75], a[8:11], v[80:95]
    s_or_b64 s[42:43], vcc, s[38:39]
    v_exp_f32 v136, v72
    v_exp_f32 v137, v73
    v_exp_f32 v138, v74
    v_mfma_f32_32x32x16_bf16 v[80:95], a[76:79], a[12:15], v[80:95]
    v_exp_f32 v139, v75
    v_exp_f32 v140, v76
    v_exp_f32_e64 v141, v77
    v_mfma_f32_32x32x8_bf16 v[80:95], a[178:179], a[248:249], v[80:95]
    v_exp_f32 v142, v78
    v_exp_f32 v143, v79
    v_add_f32 v128, 1.0, v128
    v_add_f32 v129, 1.0, v129
    v_add_f32 v130, 1.0, v130
    v_add_f32 v131, 1.0, v131
    v_add_f32 v132, 1.0, v132
    v_add_f32 v133, 1.0, v133
    v_cmp_class_f32 s[40:41], v16, s58
    v_pk_add_f32 v[134:135], v[134:135], 1.0 op_sel_hi:[1,0]
    v_pk_add_f32 v[136:137], v[136:137], 1.0 op_sel_hi:[1,0]
    v_pk_add_f32 v[138:139], v[138:139], 1.0 op_sel_hi:[1,0]
    v_pk_add_f32 v[140:141], v[140:141], 1.0 op_sel_hi:[1,0]
    v_pk_add_f32 v[142:143], v[142:143], 1.0 op_sel_hi:[1,0]
    s_or_b64 s[42:43], s[42:43], s[40:41]
    s_cbranch_scc1 K_RARE_A
K_RARE_A_RET:
    v_mfma_f32_32x32x16_bf16 v[240:255], a[160:163], a[32:35], 0
    ds_write_b32 v8, v55 offset:46400
    v_cvt_pk_bf16_f32 v16, v16, v17
    v_cvt_pk_bf16_f32 v17, v18, v19
    v_cvt_pk_bf16_f32 v18, v20, v21
    v_cvt_pk_bf16_f32 v19, v22, v23
    v_mfma_f32_32x32x16_bf16 v[240:255], a[164:167], a[36:39], v[240:255]
    v_cvt_pk_bf16_f32 v20, v24, v25
    v_cvt_pk_bf16_f32 v21, v26, v27
    v_cvt_pk_bf16_f32 v22, v28, v29
    v_cvt_pk_bf16_f32 v23, v30, v31
    v_cvt_pk_bf16_f32 v24, v32, v33
    v_cvt_pk_bf16_f32 v25, v34, v35
    v_mfma_f32_32x32x16_bf16 v[240:255], a[168:171], a[40:43], v[240:255]
    ds_write_b128 v53, v[16:19] offset:46336
    v_cvt_pk_bf16_f32 v26, v36, v37
    v_mfma_f32_32x32x16_bf16 v[240:255], a[172:175], a[44:47], v[240:255]
    v_cvt_pk_bf16_f32 v27, v38, v39
    v_cvt_pk_bf16_f32 v28, v40, v41
    v_cvt_pk_bf16_f32 v29, v42, v43
    v_cvt_pk_bf16_f32 v30, v44, v45
    v_cvt_pk_bf16_f32 v31, v46, v47
    v_exp_f32_e64 v144, v80
    v_mfma_f32_32x32x16_bf16 v[96:111], a[80:83], a[0:3], v[224:239]
    ds_write_b128 v53, v[20:23] offset:46352
    buffer_load_dwordx4 a[32:35], v0, s[4:7], 0 offen offset:0
    v_mfma_f32_32x32x16_bf16 v[96:111], a[84:87], a[4:7], v[96:111]
    ds_write_b128 v53, v[24:27] offset:46368
    buffer_load_dwordx4 a[36:39], v0, s[4:7], 0 offen offset:16
    v_mfma_f32_32x32x16_bf16 v[96:111], a[88:91], a[8:11], v[96:111]
    ds_write_b128 v53, v[28:31] offset:46384
    buffer_load_dwordx4 a[40:43], v0, s[4:7], 0 offen offset:32
    v_mfma_f32_32x32x16_bf16 v[96:111], a[92:95], a[12:15], v[96:111]
    buffer_load_dwordx4 a[44:47], v0, s[4:7], 0 offen offset:48
    ds_read2_b32 v[48:49], v9 offset0:32 offset1:68
    ds_read2_b32 v[50:51], v9 offset0:104 offset1:140
    ds_read_b128 v[32:35], v10 offset:0
    ds_read_b128 v[36:39], v10 offset:144
    ds_read_b128 v[40:43], v10 offset:288
    ds_read_b128 v[44:47], v10 offset:432
    v_mfma_f32_32x32x8_bf16 v[96:111], a[180:181], a[248:249], v[96:111]
    v_exp_f32 v145, v81
    v_exp_f32 v146, v82
    v_exp_f32 v147, v83
    v_exp_f32 v148, v84
    v_exp_f32 v149, v85
    v_exp_f32 v150, v86
    v_exp_f32 v151, v87
    v_exp_f32 v152, v88
    v_exp_f32 v153, v89
    v_exp_f32 v154, v90
    v_exp_f32 v155, v91
    v_exp_f32 v156, v92
    v_exp_f32 v157, v93
    v_exp_f32 v158, v94
    v_exp_f32_e64 v159, v95
    v_pk_add_f32 v[144:145], v[144:145], 1.0 op_sel_hi:[1,0]
    v_pk_add_f32 v[146:147], v[146:147], 1.0 op_sel_hi:[1,0]
    v_pk_add_f32 v[148:149], v[148:149], 1.0 op_sel_hi:[1,0]
    v_pk_add_f32 v[150:151], v[150:151], 1.0 op_sel_hi:[1,0]
    v_pk_add_f32 v[152:153], v[152:153], 1.0 op_sel_hi:[1,0]
    v_pk_add_f32 v[154:155], v[154:155], 1.0 op_sel_hi:[1,0]
    v_pk_add_f32 v[156:157], v[156:157], 1.0 op_sel_hi:[1,0]
    v_pk_add_f32 v[158:159], v[158:159], 1.0 op_sel_hi:[1,0]
    v_mfma_f32_32x32x16_bf16 v[112:127], a[96:99], a[0:3], v[240:255]
    s_waitcnt vmcnt(4) lgkmcnt(0)
    v_or_b32 v48, v48, v11
    v_or_b32 v49, v49, v11
    v_or_b32 v50, v50, v11
    v_or_b32_e64 v51, v51, v11
    v_mad_u32_u16 v0, v13, s59, v1 op_sel:[1,0,0,0]
    v_exp_f32_e64 v160, v96
    v_mfma_f32_32x32x16_bf16 v[112:127], a[100:103], a[4:7], v[112:127]
    buffer_store_dwordx4 v[32:35], v48, s[8:11], 0 offen sc1
    buffer_store_dwordx4 v[36:39], v49, s[8:11], 0 offen sc1
    v_mfma_f32_32x32x16_bf16 v[112:127], a[104:107], a[8:11], v[112:127]
    buffer_store_dwordx4 v[40:43], v50, s[8:11], 0 offen sc1
    buffer_store_dwordx4 v[44:47], v51, s[8:11], 0 offen sc1
    v_mfma_f32_32x32x16_bf16 v[112:127], a[108:111], a[12:15], v[112:127]
    buffer_load_dwordx4 a[0:3], v0, s[4:7], 0 offen offset:0
    v_exp_f32 v161, v97
    v_exp_f32 v162, v98
    v_exp_f32_e64 v163, v99
    v_mfma_f32_32x32x8_bf16 v[112:127], a[182:183], a[248:249], v[112:127]
    v_exp_f32 v164, v100
    v_exp_f32 v165, v101
    v_exp_f32 v166, v102
    v_exp_f32 v167, v103
    v_exp_f32 v168, v104
    v_exp_f32 v169, v105
    v_exp_f32 v170, v106
    v_exp_f32 v171, v107
    v_exp_f32 v172, v108
    v_exp_f32 v173, v109
    v_exp_f32 v174, v110
    v_exp_f32 v175, v111
    v_pk_add_f32 v[160:161], v[160:161], 1.0 op_sel_hi:[1,0]
    v_pk_add_f32 v[162:163], v[162:163], 1.0 op_sel_hi:[1,0]
    v_pk_add_f32 v[164:165], v[164:165], 1.0 op_sel_hi:[1,0]
    v_pk_add_f32 v[166:167], v[166:167], 1.0 op_sel_hi:[1,0]
    v_pk_add_f32 v[168:169], v[168:169], 1.0 op_sel_hi:[1,0]
    v_pk_add_f32 v[170:171], v[170:171], 1.0 op_sel_hi:[1,0]
    v_pk_add_f32 v[172:173], v[172:173], 1.0 op_sel_hi:[1,0]
    v_pk_add_f32 v[174:175], v[174:175], 1.0 op_sel_hi:[1,0]
    v_mfma_f32_32x32x16_bf16 v[16:31], a[48:51], a[16:19], v[192:207]
    v_exp_f32 v176, v112
    v_exp_f32 v177, v113
    v_exp_f32_e64 v178, v114
    v_mfma_f32_32x32x16_bf16 v[16:31], a[52:55], a[20:23], v[16:31]
    v_exp_f32 v179, v115
    v_exp_f32 v180, v116
    v_exp_f32_e64 v181, v117
    v_mfma_f32_32x32x16_bf16 v[16:31], a[56:59], a[24:27], v[16:31]
    v_exp_f32 v182, v118
    v_exp_f32 v183, v119
    v_exp_f32_e64 v184, v120
    v_mfma_f32_32x32x16_bf16 v[16:31], a[60:63], a[28:31], v[16:31]
    buffer_load_dwordx4 a[4:7], v0, s[4:7], 0 offen offset:16
    v_exp_f32 v185, v121
    v_exp_f32 v186, v122
    v_exp_f32_e64 v187, v123
    v_mfma_f32_32x32x8_bf16 v[16:31], a[176:177], a[250:251], v[16:31]
    v_exp_f32 v188, v124
    v_exp_f32 v189, v125
    v_exp_f32 v190, v126
    v_exp_f32 v191, v127
    v_pk_add_f32 v[176:177], v[176:177], 1.0 op_sel_hi:[1,0]
    v_pk_add_f32 v[178:179], v[178:179], 1.0 op_sel_hi:[1,0]
    v_pk_add_f32 v[180:181], v[180:181], 1.0 op_sel_hi:[1,0]
    v_pk_add_f32 v[182:183], v[182:183], 1.0 op_sel_hi:[1,0]
    v_pk_add_f32 v[184:185], v[184:185], 1.0 op_sel_hi:[1,0]
    v_pk_add_f32 v[186:187], v[186:187], 1.0 op_sel_hi:[1,0]
    v_pk_add_f32 v[188:189], v[188:189], 1.0 op_sel_hi:[1,0]
    v_pk_add_f32 v[190:191], v[190:191], 1.0 op_sel_hi:[1,0]
    s_branch K_A1X
.p2align 12
PG5:
    s_branch K_WARM_RET2
    s_nop 0
K_LOOP1X:
    buffer_load_dwordx4 a[0:3], v0, s[4:7], 0 offen offset:0
    v_exp_f32 v60, v28
    v_exp_f32 v61, v29
    v_exp_f32 v62, v30
    v_exp_f32 v63, v31
    v_pk_fma_f32 v[96:97], v[96:97], v[48:49], v[96:97]
    v_pk_fma_f32 v[98:99], v[98:99], v[50:51], v[98:99]
    v_pk_fma_f32 v[100:101], v[100:101], v[52:53], v[100:101]
    v_pk_fma_f32 v[102:103], v[102:103], v[54:55], v[102:103]
    v_pk_fma_f32 v[104:105], v[104:105], v[56:57], v[104:105]
    v_pk_fma_f32 v[106:107], v[106:107], v[58:59], v[106:107]
    v_pk_fma_f32 v[108:109], v[108:109], v[60:61], v[108:109]
    v_pk_fma_f32 v[110:111], v[110:111], v[62:63], v[110:111]
    v_pk_fma_f32 v[96:97], v[16:17], v[160:161], v[96:97]
    v_pk_fma_f32 v[98:99], v[18:19], v[162:163], v[98:99]
    v_pk_fma_f32 v[100:101], v[20:21], v[164:165], v[100:101]
    v_pk_fma_f32 v[102:103], v[22:23], v[166:167], v[102:103]
    v_pk_fma_f32 v[104:105], v[24:25], v[168:169], v[104:105]
    v_pk_fma_f32 v[106:107], v[26:27], v[170:171], v[106:107]
    v_pk_fma_f32 v[108:109], v[28:29], v[172:173], v[108:109]
    v_pk_fma_f32 v[110:111], v[30:31], v[174:175], v[110:111]
    v_pk_fma_f32 v[160:161], v[160:161], v[48:49], v[160:161]
    v_pk_fma_f32 v[162:163], v[162:163], v[50:51], v[162:163]
    v_pk_fma_f32 v[164:165], v[164:165], v[52:53], v[164:165]
    v_pk_fma_f32 v[166:167], v[166:167], v[54:55], v[166:167]
    v_pk_fma_f32 v[168:169], v[168:169], v[56:57], v[168:169]
    v_pk_fma_f32 v[170:171], v[170:171], v[58:59], v[170:171]
    v_pk_fma_f32 v[172:173], v[172:173], v[60:61], v[172:173]
    v_pk_fma_f32 v[174:175], v[174:175], v[62:63], v[174:175]
    v_mfma_f32_32x32x16_bf16 v[16:31], a[48:51], a[16:19], v[192:207]
    s_add_u32 s19, s19, 1
    v_exp_f32 v48, v32
    v_exp_f32 v49, v33
    v_exp_f32 v50, v34
    v_mfma_f32_32x32x16_bf16 v[16:31], a[52:55], a[20:23], v[16:31]
    v_exp_f32 v51, v35
    v_exp_f32 v52, v36
    v_exp_f32_e64 v53, v37
    v_mfma_f32_32x32x16_bf16 v[16:31], a[56:59], a[24:27], v[16:31]
    v_exp_f32 v54, v38
    v_exp_f32 v55, v39
    v_exp_f32_e64 v56, v40
    v_mfma_f32_32x32x16_bf16 v[16:31], a[60:63], a[28:31], v[16:31]
    buffer_load_dwordx4 a[4:7], v0, s[4:7], 0 offen offset:16
    v_exp_f32 v57, v41
    v_exp_f32 v58, v42
    v_exp_f32_e64 v59, v43
    v_mfma_f32_32x32x8_bf16 v[16:31], a[176:177], a[250:251], v[16:31]
    v_and_b32 v4, v14, v6
    v_add_u32 v2, 12, v2
    v_exp_f32 v60, v44
    v_exp_f32 v61, v45
    v_exp_f32 v62, v46
    v_exp_f32 v63, v47
    v_pk_fma_f32 v[112:113], v[112:113], v[48:49], v[112:113]
    v_pk_fma_f32 v[114:115], v[114:115], v[50:51], v[114:115]
    v_pk_fma_f32 v[116:117], v[116:117], v[52:53], v[116:117]
    v_pk_fma_f32 v[118:119], v[118:119], v[54:55], v[118:119]
    v_pk_fma_f32 v[120:121], v[120:121], v[56:57], v[120:121]
    v_pk_fma_f32 v[122:123], v[122:123], v[58:59], v[122:123]
    v_pk_fma_f32 v[124:125], v[124:125], v[60:61], v[124:125]
    v_pk_fma_f32 v[126:127], v[126:127], v[62:63], v[126:127]
    v_pk_fma_f32 v[112:113], v[32:33], v[176:177], v[112:113]
    v_pk_fma_f32 v[114:115], v[34:35], v[178:179], v[114:115]
    v_pk_fma_f32 v[116:117], v[36:37], v[180:181], v[116:117]
    v_pk_fma_f32 v[118:119], v[38:39], v[182:183], v[118:119]
    v_pk_fma_f32 v[120:121], v[40:41], v[184:185], v[120:121]
    v_pk_fma_f32 v[122:123], v[42:43], v[186:187], v[122:123]
    v_pk_fma_f32 v[124:125], v[44:45], v[188:189], v[124:125]
    v_pk_fma_f32 v[126:127], v[46:47], v[190:191], v[126:127]
    v_pk_fma_f32 v[176:177], v[176:177], v[48:49], v[176:177]
    v_pk_fma_f32 v[178:179], v[178:179], v[50:51], v[178:179]
    v_pk_fma_f32 v[180:181], v[180:181], v[52:53], v[180:181]
    v_pk_fma_f32 v[182:183], v[182:183], v[54:55], v[182:183]
    v_pk_fma_f32 v[184:185], v[184:185], v[56:57], v[184:185]
    v_pk_fma_f32 v[186:187], v[186:187], v[58:59], v[186:187]
    v_pk_fma_f32 v[188:189], v[188:189], v[60:61], v[188:189]
    v_pk_fma_f32 v[190:191], v[190:191], v[62:63], v[190:191]
K_A1X:
    v_mfma_f32_32x32x16_bf16 v[32:47], a[64:67], a[16:19], v[208:223]
    ds_read_b32 v6, v2 offset:20
    v_exp_f32 v48, v16
    v_exp_f32 v49, v17
    v_exp_f32_e64 v50, v18
    v_mfma_f32_32x32x16_bf16 v[32:47], a[68:71], a[20:23], v[32:47]
    v_exp_f32 v51, v19
    v_exp_f32 v52, v20
    v_exp_f32_e64 v53, v21
    v_mfma_f32_32x32x16_bf16 v[32:47], a[72:75], a[24:27], v[32:47]
    v_exp_f32 v54, v22
    v_exp_f32 v55, v23
    v_exp_f32_e64 v56, v24
    v_mfma_f32_32x32x16_bf16 v[32:47], a[76:79], a[28:31], v[32:47]
    buffer_load_dwordx4 a[8:11], v0, s[4:7], 0 offen offset:32
    v_exp_f32 v57, v25
    v_exp_f32 v58, v26
    v_exp_f32_e64 v59, v27
    v_mfma_f32_32x32x8_bf16 v[32:47], a[178:179], a[250:251], v[32:47]
    v_cmpx_lt_u32 vcc, s19, v3
    v_exp_f32 v60, v28
    v_exp_f32 v61, v29
    v_exp_f32 v62, v30
    v_exp_f32_e64 v63, v31
    v_pk_fma_f32 v[64:65], v[64:65], v[48:49], v[64:65]
    v_pk_fma_f32 v[66:67], v[66:67], v[50:51], v[66:67]
    v_pk_fma_f32 v[68:69], v[68:69], v[52:53], v[68:69]
    v_pk_fma_f32 v[70:71], v[70:71], v[54:55], v[70:71]
    v_pk_fma_f32 v[72:73], v[72:73], v[56:57], v[72:73]
    v_pk_fma_f32 v[74:75], v[74:75], v[58:59], v[74:75]
    v_pk_fma_f32 v[76:77], v[76:77], v[60:61], v[76:77]
    v_pk_fma_f32 v[78:79], v[78:79], v[62:63], v[78:79]
    v_pk_fma_f32 v[64:65], v[16:17], v[128:129], v[64:65]
    v_pk_fma_f32 v[66:67], v[18:19], v[130:131], v[66:67]
    v_pk_fma_f32 v[68:69], v[20:21], v[132:133], v[68:69]
    v_pk_fma_f32 v[70:71], v[22:23], v[134:135], v[70:71]
    v_pk_fma_f32 v[72:73], v[24:25], v[136:137], v[72:73]
    v_pk_fma_f32 v[74:75], v[26:27], v[138:139], v[74:75]
    v_pk_fma_f32 v[76:77], v[28:29], v[140:141], v[76:77]
    v_pk_fma_f32 v[78:79], v[30:31], v[142:143], v[78:79]
    v_pk_fma_f32 v[128:129], v[128:129], v[48:49], v[128:129]
    v_pk_fma_f32 v[130:131], v[130:131], v[50:51], v[130:131]
    v_pk_fma_f32 v[132:133], v[132:133], v[52:53], v[132:133]
    v_pk_fma_f32 v[134:135], v[134:135], v[54:55], v[134:135]
    v_pk_fma_f32 v[136:137], v[136:137], v[56:57], v[136:137]
    v_pk_fma_f32 v[138:139], v[138:139], v[58:59], v[138:139]
    v_pk_fma_f32 v[140:141], v[140:141], v[60:61], v[140:141]
    v_pk_fma_f32 v[142:143], v[142:143], v[62:63], v[142:143]
    v_mfma_f32_32x32x16_bf16 v[16:31], a[80:83], a[16:19], v[224:239]
    v_exp_f32 v48, v32
    v_exp_f32 v49, v33
    v_exp_f32_e64 v50, v34
    v_mfma_f32_32x32x16_bf16 v[16:31], a[84:87], a[20:23], v[16:31]
    s_cmp_lt_i32 s19, s37
    v_exp_f32 v51, v35
    v_exp_f32 v52, v36
    v_exp_f32 v53, v37
    v_mfma_f32_32x32x16_bf16 v[16:31], a[88:91], a[24:27], v[16:31]
    s_waitcnt lgkmcnt(0)
    v_exp_f32 v54, v38
    v_exp_f32 v55, v39
    v_exp_f32 v56, v40
    v_mfma_f32_32x32x16_bf16 v[16:31], a[92:95], a[28:31], v[16:31]
    buffer_load_dwordx4 a[12:15], v0, s[4:7], 0 offen offset:48
    v_exp_f32 v57, v41
    v_exp_f32 v58, v42
    v_exp_f32_e64 v59, v43
    v_mfma_f32_32x32x8_bf16 v[16:31], a[180:181], a[250:251], v[16:31]
    v_mad_u32_u16 v0, v6, s59, v1 op_sel:[1,0,0,0]
    v_exp_f32 v60, v44
    v_exp_f32 v61, v45
    v_exp_f32 v62, v46
    v_exp_f32 v63, v47
    v_pk_fma_f32 v[80:81], v[80:81], v[48:49], v[80:81]
    v_pk_fma_f32 v[82:83], v[82:83], v[50:51], v[82:83]
    v_pk_fma_f32 v[84:85], v[84:85], v[52:53], v[84:85]
    v_pk_fma_f32 v[86:87], v[86:87], v[54:55], v[86:87]
    v_pk_fma_f32 v[88:89], v[88:89], v[56:57], v[88:89]
    v_pk_fma_f32 v[90:91], v[90:91], v[58:59], v[90:91]
    v_pk_fma_f32 v[92:93], v[92:93], v[60:61], v[92:93]
    v_pk_fma_f32 v[94:95], v[94:95], v[62:63], v[94:95]
    v_pk_fma_f32 v[80:81], v[32:33], v[144:145], v[80:81]
    v_pk_fma_f32 v[82:83], v[34:35], v[146:147], v[82:83]
    v_pk_fma_f32 v[84:85], v[36:37], v[148:149], v[84:85]
    v_pk_fma_f32 v[86:87], v[38:39], v[150:151], v[86:87]
    v_pk_fma_f32 v[88:89], v[40:41], v[152:153], v[88:89]
    v_pk_fma_f32 v[90:91], v[42:43], v[154:155], v[90:91]
    v_pk_fma_f32 v[92:93], v[44:45], v[156:157], v[92:93]
    v_pk_fma_f32 v[94:95], v[46:47], v[158:159], v[94:95]
    v_pk_fma_f32 v[144:145], v[144:145], v[48:49], v[144:145]
    v_pk_fma_f32 v[146:147], v[146:147], v[50:51], v[146:147]
    v_pk_fma_f32 v[148:149], v[148:149], v[52:53], v[148:149]
    v_pk_fma_f32 v[150:151], v[150:151], v[54:55], v[150:151]
    v_pk_fma_f32 v[152:153], v[152:153], v[56:57], v[152:153]
    v_pk_fma_f32 v[154:155], v[154:155], v[58:59], v[154:155]
    v_pk_fma_f32 v[156:157], v[156:157], v[60:61], v[156:157]
    v_pk_fma_f32 v[158:159], v[158:159], v[62:63], v[158:159]
    v_mfma_f32_32x32x16_bf16 v[32:47], a[96:99], a[16:19], v[240:255]
    s_cselect_b32 s6, s26, 0
    v_exp_f32 v48, v16
    v_exp_f32 v49, v17
    v_exp_f32 v50, v18
    v_mfma_f32_32x32x16_bf16 v[32:47], a[100:103], a[20:23], v[32:47]
    s_cmp_ge_u32 s19, s20
    v_exp_f32 v51, v19
    v_exp_f32 v52, v20
    v_exp_f32 v53, v21
    v_mfma_f32_32x32x16_bf16 v[32:47], a[104:107], a[24:27], v[32:47]
    s_waitcnt vmcnt(4)
    v_exp_f32 v54, v22
    v_exp_f32 v55, v23
    v_exp_f32 v56, v24
    v_mfma_f32_32x32x16_bf16 v[32:47], a[108:111], a[28:31], v[32:47]
    ds_read_b64 a[248:249], v4
    v_exp_f32 v57, v25
    v_exp_f32 v58, v26
    v_exp_f32_e64 v59, v27
    v_mfma_f32_32x32x8_bf16 v[32:47], a[182:183], a[250:251], v[32:47]
    s_cbranch_scc1 K_LAST
    buffer_load_dwordx4 a[16:19], v0, s[4:7], 0 offen offset:0
    v_exp_f32 v60, v28
    v_exp_f32 v61, v29
    v_exp_f32 v62, v30
    v_exp_f32_e64 v63, v31
    v_pk_fma_f32 v[96:97], v[96:97], v[48:49], v[96:97]
    v_pk_fma_f32 v[98:99], v[98:99], v[50:51], v[98:99]
    v_pk_fma_f32 v[100:101], v[100:101], v[52:53], v[100:101]
    v_pk_fma_f32 v[102:103], v[102:103], v[54:55], v[102:103]
    v_pk_fma_f32 v[104:105], v[104:105], v[56:57], v[104:105]
    v_pk_fma_f32 v[106:107], v[106:107], v[58:59], v[106:107]
    v_pk_fma_f32 v[108:109], v[108:109], v[60:61], v[108:109]
    v_pk_fma_f32 v[110:111], v[110:111], v[62:63], v[110:111]
    v_pk_fma_f32 v[96:97], v[16:17], v[160:161], v[96:97]
    v_pk_fma_f32 v[98:99], v[18:19], v[162:163], v[98:99]
    v_pk_fma_f32 v[100:101], v[20:21], v[164:165], v[100:101]
    v_pk_fma_f32 v[102:103], v[22:23], v[166:167], v[102:103]
    v_pk_fma_f32 v[104:105], v[24:25], v[168:169], v[104:105]
    v_pk_fma_f32 v[106:107], v[26:27], v[170:171], v[106:107]
    v_pk_fma_f32 v[108:109], v[28:29], v[172:173], v[108:109]
    v_pk_fma_f32 v[110:111], v[30:31], v[174:175], v[110:111]
    v_pk_fma_f32 v[160:161], v[160:161], v[48:49], v[160:161]
    v_pk_fma_f32 v[162:163], v[162:163], v[50:51], v[162:163]
    v_pk_fma_f32 v[164:165], v[164:165], v[52:53], v[164:165]
    v_pk_fma_f32 v[166:167], v[166:167], v[54:55], v[166:167]
    v_pk_fma_f32 v[168:169], v[168:169], v[56:57], v[168:169]
    v_pk_fma_f32 v[170:171], v[170:171], v[58:59], v[170:171]
    v_pk_fma_f32 v[172:173], v[172:173], v[60:61], v[172:173]
    v_pk_fma_f32 v[174:175], v[174:175], v[62:63], v[174:175]
    v_mfma_f32_32x32x16_bf16 v[16:31], a[48:51], a[32:35], v[192:207]
    s_add_u32 s19, s19, 1
    v_exp_f32 v48, v32
    v_exp_f32 v49, v33
    v_exp_f32 v50, v34
    v_mfma_f32_32x32x16_bf16 v[16:31], a[52:55], a[36:39], v[16:31]
    v_exp_f32 v51, v35
    v_exp_f32 v52, v36
    v_exp_f32_e64 v53, v37
    v_mfma_f32_32x32x16_bf16 v[16:31], a[56:59], a[40:43], v[16:31]
    v_exp_f32 v54, v38
    v_exp_f32 v55, v39
    v_exp_f32_e64 v56, v40
    v_mfma_f32_32x32x16_bf16 v[16:31], a[60:63], a[44:47], v[16:31]
    buffer_load_dwordx4 a[20:23], v0, s[4:7], 0 offen offset:16
    v_exp_f32 v57, v41
    v_exp_f32 v58, v42
    v_exp_f32_e64 v59, v43
    v_mfma_f32_32x32x8_bf16 v[16:31], a[176:177], a[252:253], v[16:31]
    v_and_b32 v4, v14, v6
    v_exp_f32 v60, v44
    v_exp_f32 v61, v45
    v_exp_f32 v62, v46
    v_exp_f32_e64 v63, v47
    v_pk_fma_f32 v[112:113], v[112:113], v[48:49], v[112:113]
    v_pk_fma_f32 v[114:115], v[114:115], v[50:51], v[114:115]
    v_pk_fma_f32 v[116:117], v[116:117], v[52:53], v[116:117]
    v_pk_fma_f32 v[118:119], v[118:119], v[54:55], v[118:119]
    v_pk_fma_f32 v[120:121], v[120:121], v[56:57], v[120:121]
    v_pk_fma_f32 v[122:123], v[122:123], v[58:59], v[122:123]
    v_pk_fma_f32 v[124:125], v[124:125], v[60:61], v[124:125]
    v_pk_fma_f32 v[126:127], v[126:127], v[62:63], v[126:127]
    v_pk_fma_f32 v[112:113], v[32:33], v[176:177], v[112:113]
    v_pk_fma_f32 v[114:115], v[34:35], v[178:179], v[114:115]
    v_pk_fma_f32 v[116:117], v[36:37], v[180:181], v[116:117]
    v_pk_fma_f32 v[118:119], v[38:39], v[182:183], v[118:119]
    v_pk_fma_f32 v[120:121], v[40:41], v[184:185], v[120:121]
    v_pk_fma_f32 v[122:123], v[42:43], v[186:187], v[122:123]
    v_pk_fma_f32 v[124:125], v[44:45], v[188:189], v[124:125]
    v_pk_fma_f32 v[126:127], v[46:47], v[190:191], v[126:127]
    v_pk_fma_f32 v[176:177], v[176:177], v[48:49], v[176:177]
    v_pk_fma_f32 v[178:179], v[178:179], v[50:51], v[178:179]
    v_pk_fma_f32 v[180:181], v[180:181], v[52:53], v[180:181]
    v_pk_fma_f32 v[182:183], v[182:183], v[54:55], v[182:183]
    v_pk_fma_f32 v[184:185], v[184:185], v[56:57], v[184:185]
    v_pk_fma_f32 v[186:187], v[186:187], v[58:59], v[186:187]
    v_pk_fma_f32 v[188:189], v[188:189], v[60:61], v[188:189]
    v_pk_fma_f32 v[190:191], v[190:191], v[62:63], v[190:191]
    v_mfma_f32_32x32x16_bf16 v[32:47], a[64:67], a[32:35], v[208:223]
    ds_read_b32 v6, v2 offset:24
    v_exp_f32 v48, v16
    v_exp_f32 v49, v17
    v_exp_f32_e64 v50, v18
    v_mfma_f32_32x32x16_bf16 v[32:47], a[68:71], a[36:39], v[32:47]
    v_exp_f32 v51, v19
    v_exp_f32 v52, v20
    v_exp_f32_e64 v53, v21
    v_mfma_f32_32x32x16_bf16 v[32:47], a[72:75], a[40:43], v[32:47]
    v_exp_f32 v54, v22
    v_exp_f32 v55, v23
    v_exp_f32_e64 v56, v24
    v_mfma_f32_32x32x16_bf16 v[32:47], a[76:79], a[44:47], v[32:47]
    buffer_load_dwordx4 a[24:27], v0, s[4:7], 0 offen offset:32
    v_exp_f32 v57, v25
    v_exp_f32 v58, v26
    v_exp_f32_e64 v59, v27
    v_mfma_f32_32x32x8_bf16 v[32:47], a[178:179], a[252:253], v[32:47]
    v_cmpx_lt_u32 vcc, s19, v3
    v_exp_f32 v60, v28
    v_exp_f32 v61, v29
    v_exp_f32 v62, v30
    v_exp_f32_e64 v63, v31
    v_pk_fma_f32 v[64:65], v[64:65], v[48:49], v[64:65]
    v_pk_fma_f32 v[66:67], v[66:67], v[50:51], v[66:67]
    v_pk_fma_f32 v[68:69], v[68:69], v[52:53], v[68:69]
    v_pk_fma_f32 v[70:71], v[70:71], v[54:55], v[70:71]
    v_pk_fma_f32 v[72:73], v[72:73], v[56:57], v[72:73]
    v_pk_fma_f32 v[74:75], v[74:75], v[58:59], v[74:75]
    v_pk_fma_f32 v[76:77], v[76:77], v[60:61], v[76:77]
    v_pk_fma_f32 v[78:79], v[78:79], v[62:63], v[78:79]
    v_pk_fma_f32 v[64:65], v[16:17], v[128:129], v[64:65]
    v_pk_fma_f32 v[66:67], v[18:19], v[130:131], v[66:67]
    v_pk_fma_f32 v[68:69], v[20:21], v[132:133], v[68:69]
    v_pk_fma_f32 v[70:71], v[22:23], v[134:135], v[70:71]
    v_pk_fma_f32 v[72:73], v[24:25], v[136:137], v[72:73]
    v_pk_fma_f32 v[74:75], v[26:27], v[138:139], v[74:75]
    v_pk_fma_f32 v[76:77], v[28:29], v[140:141], v[76:77]
    v_pk_fma_f32 v[78:79], v[30:31], v[142:143], v[78:79]
    v_pk_fma_f32 v[128:129], v[128:129], v[48:49], v[128:129]
    v_pk_fma_f32 v[130:131], v[130:131], v[50:51], v[130:131]
    v_pk_fma_f32 v[132:133], v[132:133], v[52:53], v[132:133]
    v_pk_fma_f32 v[134:135], v[134:135], v[54:55], v[134:135]
    v_pk_fma_f32 v[136:137], v[136:137], v[56:57], v[136:137]
    v_pk_fma_f32 v[138:139], v[138:139], v[58:59], v[138:139]
    v_pk_fma_f32 v[140:141], v[140:141], v[60:61], v[140:141]
    v_pk_fma_f32 v[142:143], v[142:143], v[62:63], v[142:143]
    v_mfma_f32_32x32x16_bf16 v[16:31], a[80:83], a[32:35], v[224:239]
    v_exp_f32 v48, v32
    v_exp_f32 v49, v33
    v_exp_f32_e64 v50, v34
    v_mfma_f32_32x32x16_bf16 v[16:31], a[84:87], a[36:39], v[16:31]
    s_cmp_lt_i32 s19, s37
    v_exp_f32 v51, v35
    v_exp_f32 v52, v36
    v_exp_f32 v53, v37
    v_mfma_f32_32x32x16_bf16 v[16:31], a[88:91], a[40:43], v[16:31]
    s_waitcnt lgkmcnt(0)
    v_exp_f32 v54, v38
    v_exp_f32 v55, v39
    v_exp_f32 v56, v40
    v_mfma_f32_32x32x16_bf16 v[16:31], a[92:95], a[44:47], v[16:31]
    buffer_load_dwordx4 a[28:31], v0, s[4:7], 0 offen offset:48
    v_exp_f32 v57, v41
    v_exp_f32 v58, v42
    v_exp_f32_e64 v59, v43
    v_mfma_f32_32x32x8_bf16 v[16:31], a[180:181], a[252:253], v[16:31]
    v_mad_u32_u16 v0, v6, s59, v1 op_sel:[1,0,0,0]
    v_exp_f32 v60, v44
    v_exp_f32 v61, v45
    v_exp_f32 v62, v46
    v_exp_f32 v63, v47
    v_pk_fma_f32 v[80:81], v[80:81], v[48:49], v[80:81]
    v_pk_fma_f32 v[82:83], v[82:83], v[50:51], v[82:83]
    v_pk_fma_f32 v[84:85], v[84:85], v[52:53], v[84:85]
    v_pk_fma_f32 v[86:87], v[86:87], v[54:55], v[86:87]
    v_pk_fma_f32 v[88:89], v[88:89], v[56:57], v[88:89]
    v_pk_fma_f32 v[90:91], v[90:91], v[58:59], v[90:91]
    v_pk_fma_f32 v[92:93], v[92:93], v[60:61], v[92:93]
    v_pk_fma_f32 v[94:95], v[94:95], v[62:63], v[94:95]
    v_pk_fma_f32 v[80:81], v[32:33], v[144:145], v[80:81]
    v_pk_fma_f32 v[82:83], v[34:35], v[146:147], v[82:83]
    v_pk_fma_f32 v[84:85], v[36:37], v[148:149], v[84:85]
    v_pk_fma_f32 v[86:87], v[38:39], v[150:151], v[86:87]
    v_pk_fma_f32 v[88:89], v[40:41], v[152:153], v[88:89]
    v_pk_fma_f32 v[90:91], v[42:43], v[154:155], v[90:91]
    v_pk_fma_f32 v[92:93], v[44:45], v[156:157], v[92:93]
    v_pk_fma_f32 v[94:95], v[46:47], v[158:159], v[94:95]
    v_pk_fma_f32 v[144:145], v[144:145], v[48:49], v[144:145]
    v_pk_fma_f32 v[146:147], v[146:147], v[50:51], v[146:147]
    v_pk_fma_f32 v[148:149], v[148:149], v[52:53], v[148:149]
    v_pk_fma_f32 v[150:151], v[150:151], v[54:55], v[150:151]
    v_pk_fma_f32 v[152:153], v[152:153], v[56:57], v[152:153]
    v_pk_fma_f32 v[154:155], v[154:155], v[58:59], v[154:155]
    v_pk_fma_f32 v[156:157], v[156:157], v[60:61], v[156:157]
    v_pk_fma_f32 v[158:159], v[158:159], v[62:63], v[158:159]
    v_mfma_f32_32x32x16_bf16 v[32:47], a[96:99], a[32:35], v[240:255]
    s_cselect_b32 s6, s26, 0
    v_exp_f32 v48, v16
    v_exp_f32 v49, v17
    v_exp_f32 v50, v18
    v_mfma_f32_32x32x16_bf16 v[32:47], a[100:103], a[36:39], v[32:47]
    s_cmp_ge_u32 s19, s20
    v_exp_f32 v51, v19
    v_exp_f32 v52, v20
    v_exp_f32 v53, v21
    v_mfma_f32_32x32x16_bf16 v[32:47], a[104:107], a[40:43], v[32:47]
    s_waitcnt vmcnt(4)
    v_exp_f32 v54, v22
    v_exp_f32 v55, v23
    v_exp_f32 v56, v24
    v_mfma_f32_32x32x16_bf16 v[32:47], a[108:111], a[44:47], v[32:47]
    ds_read_b64 a[250:251], v4
    v_exp_f32 v57, v25
    v_exp_f32 v58, v26
    v_exp_f32_e64 v59, v27
    v_mfma_f32_32x32x8_bf16 v[32:47], a[182:183], a[252:253], v[32:47]
    s_cbranch_scc1 K_LAST
    buffer_load_dwordx4 a[32:35], v0, s[4:7], 0 offen offset:0
    v_exp_f32 v60, v28
    v_exp_f32 v61, v29
    v_exp_f32 v62, v30
    v_exp_f32_e64 v63, v31
    v_pk_fma_f32 v[96:97], v[96:97], v[48:49], v[96:97]
    v_pk_fma_f32 v[98:99], v[98:99], v[50:51], v[98:99]
    v_pk_fma_f32 v[100:101], v[100:101], v[52:53], v[100:101]
    v_pk_fma_f32 v[102:103], v[102:103], v[54:55], v[102:103]
    v_pk_fma_f32 v[104:105], v[104:105], v[56:57], v[104:105]
    v_pk_fma_f32 v[106:107], v[106:107], v[58:59], v[106:107]
    v_pk_fma_f32 v[108:109], v[108:109], v[60:61], v[108:109]
    v_pk_fma_f32 v[110:111], v[110:111], v[62:63], v[110:111]
    v_pk_fma_f32 v[96:97], v[16:17], v[160:161], v[96:97]
    v_pk_fma_f32 v[98:99], v[18:19], v[162:163], v[98:99]
    v_pk_fma_f32 v[100:101], v[20:21], v[164:165], v[100:101]
    v_pk_fma_f32 v[102:103], v[22:23], v[166:167], v[102:103]
    v_pk_fma_f32 v[104:105], v[24:25], v[168:169], v[104:105]
    v_pk_fma_f32 v[106:107], v[26:27], v[170:171], v[106:107]
    v_pk_fma_f32 v[108:109], v[28:29], v[172:173], v[108:109]
    v_pk_fma_f32 v[110:111], v[30:31], v[174:175], v[110:111]
    v_pk_fma_f32 v[160:161], v[160:161], v[48:49], v[160:161]
    v_pk_fma_f32 v[162:163], v[162:163], v[50:51], v[162:163]
    v_pk_fma_f32 v[164:165], v[164:165], v[52:53], v[164:165]
    v_pk_fma_f32 v[166:167], v[166:167], v[54:55], v[166:167]
    v_pk_fma_f32 v[168:169], v[168:169], v[56:57], v[168:169]
    v_pk_fma_f32 v[170:171], v[170:171], v[58:59], v[170:171]
    v_pk_fma_f32 v[172:173], v[172:173], v[60:61], v[172:173]
    v_pk_fma_f32 v[174:175], v[174:175], v[62:63], v[174:175]
    v_mfma_f32_32x32x16_bf16 v[16:31], a[48:51], a[0:3], v[192:207]
    s_add_u32 s19, s19, 1
    v_exp_f32 v48, v32
    v_exp_f32 v49, v33
    v_exp_f32 v50, v34
    v_mfma_f32_32x32x16_bf16 v[16:31], a[52:55], a[4:7], v[16:31]
    v_exp_f32 v51, v35
    v_exp_f32 v52, v36
    v_exp_f32_e64 v53, v37
    v_mfma_f32_32x32x16_bf16 v[16:31], a[56:59], a[8:11], v[16:31]
    v_exp_f32 v54, v38
    v_exp_f32 v55, v39
    v_exp_f32_e64 v56, v40
    v_mfma_f32_32x32x16_bf16 v[16:31], a[60:63], a[12:15], v[16:31]
    buffer_load_dwordx4 a[36:39], v0, s[4:7], 0 offen offset:16
    v_exp_f32 v57, v41
    v_exp_f32 v58, v42
    v_exp_f32_e64 v59, v43
    v_mfma_f32_32x32x8_bf16 v[16:31], a[176:177], a[248:249], v[16:31]
    v_and_b32 v4, v14, v6
    v_exp_f32 v60, v44
    v_exp_f32 v61, v45
    v_exp_f32 v62, v46
    v_exp_f32_e64 v63, v47
    v_pk_fma_f32 v[112:113], v[112:113], v[48:49], v[112:113]
    v_pk_fma_f32 v[114:115], v[114:115], v[50:51], v[114:115]
    v_pk_fma_f32 v[116:117], v[116:117], v[52:53], v[116:117]
    v_pk_fma_f32 v[118:119], v[118:119], v[54:55], v[118:119]
    v_pk_fma_f32 v[120:121], v[120:121], v[56:57], v[120:121]
    v_pk_fma_f32 v[122:123], v[122:123], v[58:59], v[122:123]
    v_pk_fma_f32 v[124:125], v[124:125], v[60:61], v[124:125]
    v_pk_fma_f32 v[126:127], v[126:127], v[62:63], v[126:127]
    v_pk_fma_f32 v[112:113], v[32:33], v[176:177], v[112:113]
    v_pk_fma_f32 v[114:115], v[34:35], v[178:179], v[114:115]
    v_pk_fma_f32 v[116:117], v[36:37], v[180:181], v[116:117]
    v_pk_fma_f32 v[118:119], v[38:39], v[182:183], v[118:119]
    v_pk_fma_f32 v[120:121], v[40:41], v[184:185], v[120:121]
    v_pk_fma_f32 v[122:123], v[42:43], v[186:187], v[122:123]
    v_pk_fma_f32 v[124:125], v[44:45], v[188:189], v[124:125]
    v_pk_fma_f32 v[126:127], v[46:47], v[190:191], v[126:127]
    v_pk_fma_f32 v[176:177], v[176:177], v[48:49], v[176:177]
    v_pk_fma_f32 v[178:179], v[178:179], v[50:51], v[178:179]
    v_pk_fma_f32 v[180:181], v[180:181], v[52:53], v[180:181]
    v_pk_fma_f32 v[182:183], v[182:183], v[54:55], v[182:183]
    v_pk_fma_f32 v[184:185], v[184:185], v[56:57], v[184:185]
    v_pk_fma_f32 v[186:187], v[186:187], v[58:59], v[186:187]
    v_pk_fma_f32 v[188:189], v[188:189], v[60:61], v[188:189]
    v_pk_fma_f32 v[190:191], v[190:191], v[62:63], v[190:191]
    v_mfma_f32_32x32x16_bf16 v[32:47], a[64:67], a[0:3], v[208:223]
    ds_read_b32 v6, v2 offset:28
    v_exp_f32 v48, v16
    v_exp_f32 v49, v17
    v_exp_f32_e64 v50, v18
    v_mfma_f32_32x32x16_bf16 v[32:47], a[68:71], a[4:7], v[32:47]
    v_exp_f32 v51, v19
    v_exp_f32 v52, v20
    v_exp_f32_e64 v53, v21
    v_mfma_f32_32x32x16_bf16 v[32:47], a[72:75], a[8:11], v[32:47]
    v_exp_f32 v54, v22
    v_exp_f32 v55, v23
    v_exp_f32_e64 v56, v24
    v_mfma_f32_32x32x16_bf16 v[32:47], a[76:79], a[12:15], v[32:47]
    buffer_load_dwordx4 a[40:43], v0, s[4:7], 0 offen offset:32
    v_exp_f32 v57, v25
    v_exp_f32 v58, v26
    v_exp_f32_e64 v59, v27
    v_mfma_f32_32x32x8_bf16 v[32:47], a[178:179], a[248:249], v[32:47]
    v_cmpx_lt_u32 vcc, s19, v3
    v_exp_f32 v60, v28
    v_exp_f32 v61, v29
    v_exp_f32 v62, v30
    v_exp_f32_e64 v63, v31
    v_pk_fma_f32 v[64:65], v[64:65], v[48:49], v[64:65]
    v_pk_fma_f32 v[66:67], v[66:67], v[50:51], v[66:67]
    v_pk_fma_f32 v[68:69], v[68:69], v[52:53], v[68:69]
    v_pk_fma_f32 v[70:71], v[70:71], v[54:55], v[70:71]
    v_pk_fma_f32 v[72:73], v[72:73], v[56:57], v[72:73]
    v_pk_fma_f32 v[74:75], v[74:75], v[58:59], v[74:75]
    v_pk_fma_f32 v[76:77], v[76:77], v[60:61], v[76:77]
    v_pk_fma_f32 v[78:79], v[78:79], v[62:63], v[78:79]
    v_pk_fma_f32 v[64:65], v[16:17], v[128:129], v[64:65]
    v_pk_fma_f32 v[66:67], v[18:19], v[130:131], v[66:67]
    v_pk_fma_f32 v[68:69], v[20:21], v[132:133], v[68:69]
    v_pk_fma_f32 v[70:71], v[22:23], v[134:135], v[70:71]
    v_pk_fma_f32 v[72:73], v[24:25], v[136:137], v[72:73]
    v_pk_fma_f32 v[74:75], v[26:27], v[138:139], v[74:75]
    v_pk_fma_f32 v[76:77], v[28:29], v[140:141], v[76:77]
    v_pk_fma_f32 v[78:79], v[30:31], v[142:143], v[78:79]
    v_pk_fma_f32 v[128:129], v[128:129], v[48:49], v[128:129]
    v_pk_fma_f32 v[130:131], v[130:131], v[50:51], v[130:131]
    v_pk_fma_f32 v[132:133], v[132:133], v[52:53], v[132:133]
    v_pk_fma_f32 v[134:135], v[134:135], v[54:55], v[134:135]
    v_pk_fma_f32 v[136:137], v[136:137], v[56:57], v[136:137]
    v_pk_fma_f32 v[138:139], v[138:139], v[58:59], v[138:139]
    v_pk_fma_f32 v[140:141], v[140:141], v[60:61], v[140:141]
    v_pk_fma_f32 v[142:143], v[142:143], v[62:63], v[142:143]
    v_mfma_f32_32x32x16_bf16 v[16:31], a[80:83], a[0:3], v[224:239]
    v_exp_f32 v48, v32
    v_exp_f32 v49, v33
    v_exp_f32_e64 v50, v34
    v_mfma_f32_32x32x16_bf16 v[16:31], a[84:87], a[4:7], v[16:31]
    s_cmp_lt_i32 s19, s37
    v_exp_f32 v51, v35
    v_exp_f32 v52, v36
    v_exp_f32 v53, v37
    v_mfma_f32_32x32x16_bf16 v[16:31], a[88:91], a[8:11], v[16:31]
    s_waitcnt lgkmcnt(0)
    v_exp_f32 v54, v38
    v_exp_f32 v55, v39
    v_exp_f32 v56, v40
    v_mfma_f32_32x32x16_bf16 v[16:31], a[92:95], a[12:15], v[16:31]
    buffer_load_dwordx4 a[44:47], v0, s[4:7], 0 offen offset:48
    v_exp_f32 v57, v41
    v_exp_f32 v58, v42
    v_exp_f32_e64 v59, v43
    v_mfma_f32_32x32x8_bf16 v[16:31], a[180:181], a[248:249], v[16:31]
    v_mad_u32_u16 v0, v6, s59, v1 op_sel:[1,0,0,0]
    v_exp_f32 v60, v44
    v_exp_f32 v61, v45
    v_exp_f32 v62, v46
    v_exp_f32 v63, v47
    v_pk_fma_f32 v[80:81], v[80:81], v[48:49], v[80:81]
    v_pk_fma_f32 v[82:83], v[82:83], v[50:51], v[82:83]
    v_pk_fma_f32 v[84:85], v[84:85], v[52:53], v[84:85]
    v_pk_fma_f32 v[86:87], v[86:87], v[54:55], v[86:87]
    v_pk_fma_f32 v[88:89], v[88:89], v[56:57], v[88:89]
    v_pk_fma_f32 v[90:91], v[90:91], v[58:59], v[90:91]
    v_pk_fma_f32 v[92:93], v[92:93], v[60:61], v[92:93]
    v_pk_fma_f32 v[94:95], v[94:95], v[62:63], v[94:95]
    v_pk_fma_f32 v[80:81], v[32:33], v[144:145], v[80:81]
    v_pk_fma_f32 v[82:83], v[34:35], v[146:147], v[82:83]
    v_pk_fma_f32 v[84:85], v[36:37], v[148:149], v[84:85]
    v_pk_fma_f32 v[86:87], v[38:39], v[150:151], v[86:87]
    v_pk_fma_f32 v[88:89], v[40:41], v[152:153], v[88:89]
    v_pk_fma_f32 v[90:91], v[42:43], v[154:155], v[90:91]
    v_pk_fma_f32 v[92:93], v[44:45], v[156:157], v[92:93]
    v_pk_fma_f32 v[94:95], v[46:47], v[158:159], v[94:95]
    v_pk_fma_f32 v[144:145], v[144:145], v[48:49], v[144:145]
    v_pk_fma_f32 v[146:147], v[146:147], v[50:51], v[146:147]
    v_pk_fma_f32 v[148:149], v[148:149], v[52:53], v[148:149]
    v_pk_fma_f32 v[150:151], v[150:151], v[54:55], v[150:151]
    v_pk_fma_f32 v[152:153], v[152:153], v[56:57], v[152:153]
    v_pk_fma_f32 v[154:155], v[154:155], v[58:59], v[154:155]
    v_pk_fma_f32 v[156:157], v[156:157], v[60:61], v[156:157]
    v_pk_fma_f32 v[158:159], v[158:159], v[62:63], v[158:159]
    v_mfma_f32_32x32x16_bf16 v[32:47], a[96:99], a[0:3], v[240:255]
    s_cselect_b32 s6, s26, 0
    v_exp_f32 v48, v16
    v_exp_f32 v49, v17
    v_exp_f32 v50, v18
    v_mfma_f32_32x32x16_bf16 v[32:47], a[100:103], a[4:7], v[32:47]
    s_cmp_ge_u32 s19, s20
    v_exp_f32 v51, v19
    v_exp_f32 v52, v20
    v_exp_f32 v53, v21
    v_mfma_f32_32x32x16_bf16 v[32:47], a[104:107], a[8:11], v[32:47]
    s_waitcnt vmcnt(4)
    v_exp_f32 v54, v22
    v_exp_f32 v55, v23
    v_exp_f32 v56, v24
    v_mfma_f32_32x32x16_bf16 v[32:47], a[108:111], a[12:15], v[32:47]
    ds_read_b64 a[252:253], v4
    v_exp_f32 v57, v25
    v_exp_f32 v58, v26
    v_exp_f32_e64 v59, v27
    v_mfma_f32_32x32x8_bf16 v[32:47], a[182:183], a[248:249], v[32:47]
    s_cbranch_scc0 K_LOOP1X
    s_branch K_LAST
K_EXIT1X:
.p2align 12
PG6:
    s_branch K_WARM_RET2
    s_nop 0
K_LAST:
    v_exp_f32 v60, v28
    v_exp_f32 v61, v29
    v_exp_f32 v62, v30
    v_exp_f32 v63, v31
    v_pk_fma_f32 v[96:97], v[96:97], v[48:49], v[96:97]
    v_pk_fma_f32 v[98:99], v[98:99], v[50:51], v[98:99]
    v_pk_fma_f32 v[100:101], v[100:101], v[52:53], v[100:101]
    v_pk_fma_f32 v[102:103], v[102:103], v[54:55], v[102:103]
    v_pk_fma_f32 v[104:105], v[104:105], v[56:57], v[104:105]
    v_pk_fma_f32 v[106:107], v[106:107], v[58:59], v[106:107]
    v_pk_fma_f32 v[108:109], v[108:109], v[60:61], v[108:109]
    v_pk_fma_f32 v[110:111], v[110:111], v[62:63], v[110:111]
    v_pk_fma_f32 v[96:97], v[16:17], v[160:161], v[96:97]
    v_pk_fma_f32 v[98:99], v[18:19], v[162:163], v[98:99]
    v_pk_fma_f32 v[100:101], v[20:21], v[164:165], v[100:101]
    v_pk_fma_f32 v[102:103], v[22:23], v[166:167], v[102:103]
    v_pk_fma_f32 v[104:105], v[24:25], v[168:169], v[104:105]
    v_pk_fma_f32 v[106:107], v[26:27], v[170:171], v[106:107]
    v_pk_fma_f32 v[108:109], v[28:29], v[172:173], v[108:109]
    v_pk_fma_f32 v[110:111], v[30:31], v[174:175], v[110:111]
    v_pk_fma_f32 v[160:161], v[160:161], v[48:49], v[160:161]
    v_pk_fma_f32 v[162:163], v[162:163], v[50:51], v[162:163]
    v_pk_fma_f32 v[164:165], v[164:165], v[52:53], v[164:165]
    v_pk_fma_f32 v[166:167], v[166:167], v[54:55], v[166:167]
    v_pk_fma_f32 v[168:169], v[168:169], v[56:57], v[168:169]
    v_pk_fma_f32 v[170:171], v[170:171], v[58:59], v[170:171]
    v_pk_fma_f32 v[172:173], v[172:173], v[60:61], v[172:173]
    v_pk_fma_f32 v[174:175], v[174:175], v[62:63], v[174:175]
    s_mov_b64 s[60:61], exec
    s_mov_b64 exec, -1
    v_pk_mul_f32 v[64:65], v[64:65], v[144:145]
    v_pk_mul_f32 v[66:67], v[66:67], v[146:147]
    v_pk_mul_f32 v[68:69], v[68:69], v[148:149]
    v_pk_mul_f32 v[70:71], v[70:71], v[150:151]
    v_pk_mul_f32 v[72:73], v[72:73], v[152:153]
    v_pk_mul_f32 v[74:75], v[74:75], v[154:155]
    v_pk_mul_f32 v[76:77], v[76:77], v[156:157]
    v_pk_mul_f32 v[78:79], v[78:79], v[158:159]
    v_pk_mul_f32 v[80:81], v[80:81], v[128:129]
    v_pk_mul_f32 v[82:83], v[82:83], v[130:131]
    v_pk_mul_f32 v[84:85], v[84:85], v[132:133]
    v_pk_mul_f32 v[86:87], v[86:87], v[134:135]
    v_pk_mul_f32 v[88:89], v[88:89], v[136:137]
    v_pk_mul_f32 v[90:91], v[90:91], v[138:139]
    v_pk_mul_f32 v[92:93], v[92:93], v[140:141]
    v_pk_mul_f32 v[94:95], v[94:95], v[142:143]
    v_pk_mul_f32 v[128:129], v[128:129], v[144:145]
    v_pk_mul_f32 v[130:131], v[130:131], v[146:147]
    v_pk_mul_f32 v[132:133], v[132:133], v[148:149]
    v_pk_mul_f32 v[134:135], v[134:135], v[150:151]
    v_pk_mul_f32 v[136:137], v[136:137], v[152:153]
    v_pk_mul_f32 v[138:139], v[138:139], v[154:155]
    v_pk_mul_f32 v[140:141], v[140:141], v[156:157]
    v_pk_mul_f32 v[142:143], v[142:143], v[158:159]
    v_cvt_f32_ubyte2 v226, v5
    v_mov_b32 v225, 0
    v_mov_b32 v227, 0
    v_lshrrev_b32 v224, 16, v226
    v_rcp_f32 v128, v128
    v_rcp_f32 v129, v129
    v_mfma_f32_32x32x8_bf16 v[192:207], a[254:255], v[224:225], 0
    v_rcp_f32 v130, v130
    v_rcp_f32 v131, v131
    v_rcp_f32 v132, v132
    v_rcp_f32 v133, v133
    v_mfma_f32_32x32x8_bf16 v[208:223], a[254:255], v[226:227], 0
    v_rcp_f32 v134, v134
    v_rcp_f32 v135, v135
    v_rcp_f32 v136, v136
    v_rcp_f32 v137, v137
    v_rcp_f32 v138, v138
    v_rcp_f32 v139, v139
    v_rcp_f32 v140, v140
    v_rcp_f32 v141, v141
    v_rcp_f32 v142, v142
    v_rcp_f32 v143, v143
    v_pk_mul_f32 v[64:65], v[64:65], v[128:129]
    v_pk_mul_f32 v[66:67], v[66:67], v[130:131]
    v_pk_mul_f32 v[68:69], v[68:69], v[132:133]
    v_pk_mul_f32 v[70:71], v[70:71], v[134:135]
    v_pk_mul_f32 v[72:73], v[72:73], v[136:137]
    v_pk_mul_f32 v[74:75], v[74:75], v[138:139]
    v_pk_mul_f32 v[76:77], v[76:77], v[140:141]
    v_pk_mul_f32 v[78:79], v[78:79], v[142:143]
    v_pk_mul_f32 v[80:81], v[80:81], v[128:129]
    v_pk_mul_f32 v[82:83], v[82:83], v[130:131]
    v_pk_mul_f32 v[84:85], v[84:85], v[132:133]
    v_pk_mul_f32 v[86:87], v[86:87], v[134:135]
    v_pk_mul_f32 v[88:89], v[88:89], v[136:137]
    v_pk_mul_f32 v[90:91], v[90:91], v[138:139]
    v_pk_mul_f32 v[92:93], v[92:93], v[140:141]
    v_pk_mul_f32 v[94:95], v[94:95], v[142:143]
    v_cvt_pk_bf16_f32 v64, v64, v65
    v_cvt_pk_bf16_f32 v65, v66, v67
    v_cvt_pk_bf16_f32 v66, v68, v69
    v_cvt_pk_bf16_f32 v67, v70, v71
    v_cvt_pk_bf16_f32 v68, v72, v73
    v_cvt_pk_bf16_f32 v69, v74, v75
    v_mfma_f32_32x32x16_bf16 v[192:207], a[184:187], v[64:67], v[192:207]
    v_cvt_pk_bf16_f32 v70, v76, v77
    v_cvt_pk_bf16_f32 v71, v78, v79
    v_cvt_pk_bf16_f32 v80, v80, v81
    v_cvt_pk_bf16_f32 v81, v82, v83
    v_cvt_pk_bf16_f32 v82, v84, v85
    v_cvt_pk_bf16_f32 v83, v86, v87
    v_mfma_f32_32x32x16_bf16 v[208:223], a[188:191], v[64:67], v[208:223]
    v_cvt_pk_bf16_f32 v84, v88, v89
    v_cvt_pk_bf16_f32 v85, v90, v91
    v_exp_f32 v48, v32
    v_exp_f32 v49, v33
    v_mfma_f32_32x32x16_bf16 v[192:207], a[192:195], v[68:71], v[192:207]
    v_exp_f32 v50, v34
    v_exp_f32 v51, v35
    v_exp_f32_e64 v52, v36
    v_mfma_f32_32x32x16_bf16 v[208:223], a[196:199], v[68:71], v[208:223]
    v_exp_f32 v53, v37
    v_exp_f32 v54, v38
    v_exp_f32_e64 v55, v39
    v_mfma_f32_32x32x16_bf16 v[192:207], a[200:203], v[80:83], v[192:207]
    s_mov_b64 exec, s[60:61]
    v_exp_f32 v56, v40
    v_exp_f32 v57, v41
    v_exp_f32 v58, v42
    v_exp_f32 v59, v43
    v_exp_f32 v60, v44
    v_exp_f32 v61, v45
    v_exp_f32 v62, v46
    v_exp_f32_e64 v63, v47
    v_pk_fma_f32 v[112:113], v[112:113], v[48:49], v[112:113]
    v_pk_fma_f32 v[114:115], v[114:115], v[50:51], v[114:115]
    v_pk_fma_f32 v[116:117], v[116:117], v[52:53], v[116:117]
    v_pk_fma_f32 v[118:119], v[118:119], v[54:55], v[118:119]
    v_pk_fma_f32 v[120:121], v[120:121], v[56:57], v[120:121]
    v_pk_fma_f32 v[122:123], v[122:123], v[58:59], v[122:123]
    v_pk_fma_f32 v[124:125], v[124:125], v[60:61], v[124:125]
    v_pk_fma_f32 v[126:127], v[126:127], v[62:63], v[126:127]
    v_pk_fma_f32 v[112:113], v[32:33], v[176:177], v[112:113]
    v_pk_fma_f32 v[114:115], v[34:35], v[178:179], v[114:115]
    v_pk_fma_f32 v[116:117], v[36:37], v[180:181], v[116:117]
    v_pk_fma_f32 v[118:119], v[38:39], v[182:183], v[118:119]
    v_pk_fma_f32 v[120:121], v[40:41], v[184:185], v[120:121]
    v_pk_fma_f32 v[122:123], v[42:43], v[186:187], v[122:123]
    v_pk_fma_f32 v[124:125], v[44:45], v[188:189], v[124:125]
    v_pk_fma_f32 v[126:127], v[46:47], v[190:191], v[126:127]
    v_pk_fma_f32 v[176:177], v[176:177], v[48:49], v[176:177]
    v_pk_fma_f32 v[178:179], v[178:179], v[50:51], v[178:179]
    v_pk_fma_f32 v[180:181], v[180:181], v[52:53], v[180:181]
    v_pk_fma_f32 v[182:183], v[182:183], v[54:55], v[182:183]
    v_pk_fma_f32 v[184:185], v[184:185], v[56:57], v[184:185]
    v_pk_fma_f32 v[186:187], v[186:187], v[58:59], v[186:187]
    v_pk_fma_f32 v[188:189], v[188:189], v[60:61], v[188:189]
    v_pk_fma_f32 v[190:191], v[190:191], v[62:63], v[190:191]
    s_mov_b64 exec, -1
    s_nop 0
    v_pk_mul_f32 v[96:97], v[96:97], v[176:177]
    v_pk_mul_f32 v[98:99], v[98:99], v[178:179]
    v_pk_mul_f32 v[100:101], v[100:101], v[180:181]
    v_pk_mul_f32 v[102:103], v[102:103], v[182:183]
    v_pk_mul_f32 v[104:105], v[104:105], v[184:185]
    v_pk_mul_f32 v[106:107], v[106:107], v[186:187]
    v_pk_mul_f32 v[108:109], v[108:109], v[188:189]
    v_pk_mul_f32 v[110:111], v[110:111], v[190:191]
    v_pk_mul_f32 v[112:113], v[112:113], v[160:161]
    v_pk_mul_f32 v[114:115], v[114:115], v[162:163]
    v_pk_mul_f32 v[116:117], v[116:117], v[164:165]
    v_pk_mul_f32 v[118:119], v[118:119], v[166:167]
    v_pk_mul_f32 v[120:121], v[120:121], v[168:169]
    v_pk_mul_f32 v[122:123], v[122:123], v[170:171]
    v_pk_mul_f32 v[124:125], v[124:125], v[172:173]
    v_pk_mul_f32 v[126:127], v[126:127], v[174:175]
    v_pk_mul_f32 v[160:161], v[160:161], v[176:177]
    v_pk_mul_f32 v[162:163], v[162:163], v[178:179]
    v_pk_mul_f32 v[164:165], v[164:165], v[180:181]
    v_pk_mul_f32 v[166:167], v[166:167], v[182:183]
    v_pk_mul_f32 v[168:169], v[168:169], v[184:185]
    v_pk_mul_f32 v[170:171], v[170:171], v[186:187]
    v_pk_mul_f32 v[172:173], v[172:173], v[188:189]
    v_pk_mul_f32 v[174:175], v[174:175], v[190:191]
    v_mfma_f32_32x32x16_bf16 v[208:223], a[204:207], v[80:83], v[208:223]
    v_cvt_pk_bf16_f32 v86, v92, v93
    v_cvt_pk_bf16_f32 v87, v94, v95
    v_rcp_f32 v160, v160
    v_rcp_f32 v161, v161
    v_mfma_f32_32x32x16_bf16 v[192:207], a[208:211], v[84:87], v[192:207]
    v_rcp_f32 v162, v162
    v_rcp_f32 v163, v163
    v_rcp_f32_e64 v164, v164
    v_mfma_f32_32x32x16_bf16 v[208:223], a[212:215], v[84:87], v[208:223]
    v_rcp_f32 v165, v165
    v_rcp_f32 v166, v166
    v_rcp_f32 v167, v167
    v_rcp_f32 v168, v168
    v_rcp_f32 v169, v169
    v_rcp_f32 v170, v170
    v_rcp_f32 v171, v171
    v_rcp_f32 v172, v172
    v_rcp_f32 v173, v173
    v_rcp_f32 v174, v174
    v_rcp_f32_e64 v175, v175
    v_pk_mul_f32 v[96:97], v[96:97], v[160:161]
    v_pk_mul_f32 v[98:99], v[98:99], v[162:163]
    v_pk_mul_f32 v[100:101], v[100:101], v[164:165]
    v_pk_mul_f32 v[102:103], v[102:103], v[166:167]
    v_pk_mul_f32 v[104:105], v[104:105], v[168:169]
    v_pk_mul_f32 v[106:107], v[106:107], v[170:171]
    v_pk_mul_f32 v[108:109], v[108:109], v[172:173]
    v_pk_mul_f32 v[110:111], v[110:111], v[174:175]
    v_pk_mul_f32 v[112:113], v[112:113], v[160:161]
    v_pk_mul_f32 v[114:115], v[114:115], v[162:163]
    v_pk_mul_f32 v[116:117], v[116:117], v[164:165]
    v_pk_mul_f32 v[118:119], v[118:119], v[166:167]
    v_pk_mul_f32 v[120:121], v[120:121], v[168:169]
    v_pk_mul_f32 v[122:123], v[122:123], v[170:171]
    v_pk_mul_f32 v[124:125], v[124:125], v[172:173]
    v_pk_mul_f32 v[126:127], v[126:127], v[174:175]
    v_cvt_pk_bf16_f32 v96, v96, v97
    v_cvt_pk_bf16_f32 v97, v98, v99
    v_cvt_pk_bf16_f32 v98, v100, v101
    v_cvt_pk_bf16_f32 v99, v102, v103
    v_cvt_pk_bf16_f32 v100, v104, v105
    v_cvt_pk_bf16_f32 v101, v106, v107
    v_mfma_f32_32x32x16_bf16 v[192:207], a[216:219], v[96:99], v[192:207]
    v_cvt_pk_bf16_f32 v102, v108, v109
    v_cvt_pk_bf16_f32 v103, v110, v111
    v_cvt_pk_bf16_f32 v112, v112, v113
    v_cvt_pk_bf16_f32 v113, v114, v115
    v_cvt_pk_bf16_f32 v114, v116, v117
    v_cvt_pk_bf16_f32 v115, v118, v119
    v_mfma_f32_32x32x16_bf16 v[192:207], a[224:227], v[100:103], v[192:207]
    v_cvt_pk_bf16_f32 v116, v120, v121
    v_cvt_pk_bf16_f32 v117, v122, v123
    v_cvt_pk_bf16_f32 v118, v124, v125
    v_cvt_pk_bf16_f32 v119, v126, v127
    v_min3_f32 v52, v128, v129, 1.0
    v_min3_f32 v52, v130, v131, v52
    v_mfma_f32_32x32x16_bf16 v[208:223], a[220:223], v[96:99], v[208:223]
    v_min3_f32 v52, v132, v133, v52
    v_min3_f32 v52, v134, v135, v52
    v_min3_f32 v52, v136, v137, v52
    v_min3_f32 v52, v138, v139, v52
    v_min3_f32 v52, v140, v141, v52
    v_min3_f32 v52, v142, v143, v52
    v_mfma_f32_32x32x16_bf16 v[192:207], a[232:235], v[112:115], v[192:207]
    v_min3_f32 v52, v160, v161, v52
    v_min3_f32 v52, v162, v163, v52
    v_min3_f32 v52, v164, v165, v52
    v_min3_f32 v52, v166, v167, v52
    v_min3_f32 v52, v168, v169, v52
    v_min3_f32 v52, v170, v171, v52
    v_mfma_f32_32x32x16_bf16 v[192:207], a[240:243], v[116:119], v[192:207]
    v_min3_f32 v52, v172, v173, v52
    v_min3_f32 v52, v174, v175, v52
    v_lshrrev_b32_e64 v53, 24, v5
    v_and_b32 v55, s54, v5
    v_cmp_eq_u32 vcc, s54, v53
    v_mad_u32_u24 v53, v53, s55, v1
    v_mfma_f32_32x32x16_bf16 v[208:223], a[228:231], v[100:103], v[208:223]
    v_add_lshl_u32 v55, s16, v55, 7
    v_cndmask_b32 v53, v53, v8, vcc
    v_cndmask_b32 v55, 2.0, v55, vcc
    v_cmp_eq_u32 s[38:39], 0, v226
    v_cmp_nlt_f32 vcc, s57, v52
    v_mbcnt_lo_u32_b32 v2, -1, 0
    v_mfma_f32_32x32x16_bf16 v[208:223], a[236:239], v[112:115], v[208:223]
    v_mbcnt_hi_u32_b32 v2, -1, v2
    v_lshrrev_b32 v2, 3, v2
    v_lshl_add_u32 v2, s18, 3, v2
    v_mul_u32_u24_e64 v4, s55, v2
    v_lshl_add_u32 v4, v4, 1, v11
    v_mfma_f32_32x32x16_bf16 v[208:223], a[244:247], v[116:119], v[208:223]
    v_lshl_add_u32 v2, v2, 2, s48
    s_or_b64 s[42:43], vcc, s[38:39]
    v_mov_b32 v12, 0
    v_cmp_class_f32 s[40:41], v192, s58
    v_cvt_pk_bf16_f32 v192, v192, v193
    v_cvt_pk_bf16_f32 v193, v194, v195
    v_cvt_pk_bf16_f32 v194, v196, v197
    v_cvt_pk_bf16_f32 v195, v198, v199
    v_cvt_pk_bf16_f32 v196, v200, v201
    v_cvt_pk_bf16_f32 v197, v202, v203
    v_cvt_pk_bf16_f32 v198, v204, v205
    v_cvt_pk_bf16_f32 v199, v206, v207
    v_cvt_pk_bf16_f32 v200, v208, v209
    v_cvt_pk_bf16_f32 v201, v210, v211
    v_cvt_pk_bf16_f32 v202, v212, v213
    v_cvt_pk_bf16_f32 v203, v214, v215
    v_cvt_pk_bf16_f32 v204, v216, v217
    v_cvt_pk_bf16_f32 v205, v218, v219
    v_cvt_pk_bf16_f32 v206, v220, v221
    v_cvt_pk_bf16_f32 v207, v222, v223
    s_or_b64 s[42:43], s[42:43], s[40:41]
    s_cbranch_scc1 K_RARE_B
K_RARE_B_RET:
    ds_write_b32 v8, v55 offset:46400
    ds_write_b128 v53, v[192:195] offset:46336
    ds_write_b128 v53, v[196:199] offset:46352
    ds_write_b128 v53, v[200:203] offset:46368
    ds_write_b128 v53, v[204:207] offset:46384
    ds_read2_b32 v[48:49], v9 offset0:32 offset1:68
    ds_read2_b32 v[50:51], v9 offset0:104 offset1:140
    ds_read_b128 v[32:35], v10 offset:0
    ds_read_b128 v[36:39], v10 offset:144
    ds_read_b128 v[40:43], v10 offset:288
    ds_read_b128 v[44:47], v10 offset:432
    s_waitcnt lgkmcnt(6)
    s_barrier
    ds_read_b32 v12, v12 offset:44032
    ds_read2_b32 v[2:3], v2 offset1:32
    ds_read_b128 v[64:67], v4 offset:46336
    ds_read_b128 v[68:71], v4 offset:46480
    ds_read_b128 v[72:75], v4 offset:55552
    ds_read_b128 v[76:79], v4 offset:55696
    s_waitcnt lgkmcnt(6)
    v_or_b32 v48, v48, v11
    v_or_b32 v49, v49, v11
    v_or_b32 v50, v50, v11
    v_or_b32 v51, v51, v11
    buffer_store_dwordx4 v[32:35], v48, s[8:11], 0 offen sc1
    buffer_store_dwordx4 v[36:39], v49, s[8:11], 0 offen sc1
    buffer_store_dwordx4 v[40:43], v50, s[8:11], 0 offen sc1
    buffer_store_dwordx4 v[44:47], v51, s[8:11], 0 offen sc1
    s_waitcnt lgkmcnt(2)
    v_cmp_ne_u32 vcc, 0, v12
    v_or_b32 v2, v2, v11
    v_or_b32 v3, v3, v11
    v_lshlrev_b32 v128, 16, v64
    v_and_b32 v129, s27, v64
    v_lshlrev_b32 v130, 16, v65
    v_and_b32 v131, s27, v65
    v_lshlrev_b32 v132, 16, v66
    v_and_b32 v133, s27, v66
    v_lshlrev_b32 v134, 16, v67
    v_and_b32 v135, s27, v67
    v_lshlrev_b32 v136, 16, v68
    v_and_b32 v137, s27, v68
    v_lshlrev_b32 v138, 16, v69
    v_and_b32 v139, s27, v69
    v_lshlrev_b32 v140, 16, v70
    v_and_b32 v141, s27, v70
    v_lshlrev_b32 v142, 16, v71
    v_and_b32 v143, s27, v71
    v_pk_add_f32 v[128:129], v[128:129], v[136:137]
    v_pk_add_f32 v[130:131], v[130:131], v[138:139]
    v_pk_add_f32 v[132:133], v[132:133], v[140:141]
    v_pk_add_f32 v[134:135], v[134:135], v[142:143]
    v_cvt_pk_bf16_f32 v64, v128, v129
    v_cvt_pk_bf16_f32 v65, v130, v131
    v_cvt_pk_bf16_f32 v66, v132, v133
    v_cvt_pk_bf16_f32 v67, v134, v135
    buffer_store_dwordx4 v[64:67], v2, s[8:11], 0 offen sc1
    s_waitcnt lgkmcnt(0)
    s_nop 0
    v_lshlrev_b32 v144, 16, v72
    v_and_b32 v145, s27, v72
    v_lshlrev_b32 v146, 16, v73
    v_and_b32 v147, s27, v73
    v_lshlrev_b32 v148, 16, v74
    v_and_b32 v149, s27, v74
    v_lshlrev_b32 v150, 16, v75
    v_and_b32 v151, s27, v75
    v_lshlrev_b32 v152, 16, v76
    v_and_b32 v153, s27, v76
    v_lshlrev_b32 v154, 16, v77
    v_and_b32 v155, s27, v77
    v_lshlrev_b32 v156, 16, v78
    v_and_b32 v157, s27, v78
    v_lshlrev_b32 v158, 16, v79
    v_and_b32 v159, s27, v79
    v_pk_add_f32 v[144:145], v[144:145], v[152:153]
    v_pk_add_f32 v[146:147], v[146:147], v[154:155]
    v_pk_add_f32 v[148:149], v[148:149], v[156:157]
    v_pk_add_f32 v[150:151], v[150:151], v[158:159]
    v_cvt_pk_bf16_f32 v72, v144, v145
    v_cvt_pk_bf16_f32 v73, v146, v147
    v_cvt_pk_bf16_f32 v74, v148, v149
    v_cvt_pk_bf16_f32 v75, v150, v151
    buffer_store_dwordx4 v[72:75], v3, s[8:11], 0 offen sc1
    s_cbranch_vccnz K_SLOW
K_END:
K_END0:
    s_endpgm
K_MEA:
    s_movk_i32 s3, 256
    s_add_u32 m0, s3, 0
    s_nop 0
    buffer_load_dwordx4 v190, s[12:15], s51 offen sc1 lds
    s_add_u32 m0, s3, 1024
    s_nop 0
    buffer_load_dwordx4 v191, s[12:15], s51 offen sc1 lds
    s_branch K_MEA_RET
K_RARE_A:
    s_andn2_b64 vcc, s[42:43], s[38:39]
    s_cbranch_scc0 K_RARE_A2
    v_mov_b32 v54, 0
    v_mov_b32 v52, 1
    ds_write_b32 v54, v52 offset:44032
K_RARE_A2:
    s_mov_b64 exec, s[38:39]
    v_mov_b32 v16, 0
    v_mov_b32 v17, 0
    v_mov_b32 v18, 0
    v_mov_b32 v19, 0
    v_mov_b32 v20, 0
    v_mov_b32 v21, 0
    v_mov_b32 v22, 0
    v_mov_b32 v23, 0
    v_mov_b32 v24, 0
    v_mov_b32 v25, 0
    v_mov_b32 v26, 0
    v_mov_b32 v27, 0
    v_mov_b32 v28, 0
    v_mov_b32 v29, 0
    v_mov_b32 v30, 0
    v_mov_b32 v31, 0
    v_mov_b32 v32, 0
    v_mov_b32 v33, 0
    v_mov_b32 v34, 0
    v_mov_b32 v35, 0
    v_mov_b32 v36, 0
    v_mov_b32 v37, 0
    v_mov_b32 v38, 0
    v_mov_b32 v39, 0
    v_mov_b32 v40, 0
    v_mov_b32 v41, 0
    v_mov_b32 v42, 0
    v_mov_b32 v43, 0
    v_mov_b32 v44, 0
    v_mov_b32 v45, 0
    v_mov_b32 v46, 0
    v_mov_b32 v47, 0
    s_mov_b64 exec, -1
    s_branch K_RARE_A_RET
K_RARE_B:
    s_andn2_b64 vcc, s[42:43], s[38:39]
    s_cbranch_scc0 K_RARE_B2
    v_mov_b32 v54, 0
    v_mov_b32 v52, 1
    ds_write_b32 v54, v52 offset:44032
K_RARE_B2:
    s_mov_b64 exec, s[38:39]
    v_mov_b32 v192, 0
    v_mov_b32 v193, 0
    v_mov_b32 v194, 0
    v_mov_b32 v195, 0
    v_mov_b32 v196, 0
    v_mov_b32 v197, 0
    v_mov_b32 v198, 0
    v_mov_b32 v199, 0
    v_mov_b32 v200, 0
    v_mov_b32 v201, 0
    v_mov_b32 v202, 0
    v_mov_b32 v203, 0
    v_mov_b32 v204, 0
    v_mov_b32 v205, 0
    v_mov_b32 v206, 0
    v_mov_b32 v207, 0
    s_mov_b64 exec, -1
    s_branch K_RARE_B_RET
K_MORE:
    s_sub_u32 s40, 256, s23
    s_nop 0
    s_mov_b64 exec, 1
    ds_add_rtn_u32 v188, v24, v29 offset:44036
    s_waitcnt lgkmcnt(0)
    v_cmp_ne_u32 vcc, 0, v188
    s_mov_b64 exec, -1
    s_cbranch_vccnz K_MORE_F
    v_cmp_lt_i32 vcc, 0, v33
    v_cmp_lt_i32 s[46:47], 8, v33
    v_cmp_lt_i32 s[48:49], 16, v33
    v_mbcnt_lo_u32_b32 v35, vcc_lo, 0
    v_mbcnt_hi_u32_b32 v35, vcc_hi, v35
    v_mbcnt_lo_u32_b32 v35, s46, v35
    v_mbcnt_hi_u32_b32 v35, s47, v35
    v_mbcnt_lo_u32_b32 v35, s48, v35
    v_mbcnt_hi_u32_b32 v35, s49, v35
    v_cmp_gt_u32 s[36:37], 30, v35
    v_lshlrev_b32 v35, 3, v35
    v_add_u32 v45, 8, v35
    v_add_u32 v52, 16, v35
    v_add_u32 v40, 32, v34
    v_add_u32 v53, 64, v34
    s_and_b64 vcc, vcc, s[36:37]
    s_and_b64 s[46:47], s[46:47], s[36:37]
    s_and_b64 s[48:49], s[48:49], s[36:37]
    v_cndmask_b32 v35, 4, v35, vcc
    v_cndmask_b32 v45, 4, v45, s[46:47]
    v_cndmask_b32 v52, 4, v52, s[48:49]
    ds_permute_b32 v36, v35, v34
    ds_permute_b32 v40, v45, v40
    ds_permute_b32 v53, v52, v53
    v_cndmask_b32_e64 v35, 0, 24, vcc
    v_sub_u32 v33, v33, v35
    v_lshl_add_u32 v34, v35, 2, v34
    s_waitcnt lgkmcnt(0)
    v_or3_b32 v36, v36, v40, v53
    v_lshlrev_b32 v39, 1, v36
    s_nop 0
    v_add_u32_dpp v188, v36, v31 quad_perm:[0,0,2,2] row_mask:0xf bank_mask:0xf
    buffer_load_dwordx4 v[176:179], v188, s[12:15], s50 offen sc1
    v_add_u32_dpp v190, v39, v27 quad_perm:[0,0,0,0] row_mask:0xf bank_mask:0xf
    v_add_u32_dpp v191, v39, v27 quad_perm:[2,2,2,2] row_mask:0xf bank_mask:0xf
    v_bfe_i32 v188, v188, 30, 1
    s_mov_b32 s20, 1
    s_waitcnt vmcnt(0)
    v_or_b32 v176, v188, v176
    v_or_b32 v177, v188, v177
    v_or_b32 v178, v188, v178
    v_or_b32 v179, v188, v179
    v_mad_u32_u16 v180, v176, v28, s22
    v_mad_u32_u16 v181, v177, v28, s22
    v_mad_u32_u16 v182, v178, v28, s22
    v_mad_u32_u16 v183, v179, v28, s22
    ds_add_rtn_u32 v184, v180, v29
    v_add_u32_sdwa v176, v244, s40 dst_sel:WORD_0 dst_unused:UNUSED_PRESERVE src0_sel:DWORD src1_sel:DWORD
    ds_add_rtn_u32 v185, v181, v29
    v_add_u32_sdwa v177, v245, s40 dst_sel:WORD_0 dst_unused:UNUSED_PRESERVE src0_sel:DWORD src1_sel:DWORD
    ds_add_rtn_u32 v186, v182, v29
    v_add_u32_sdwa v178, v246, s40 dst_sel:WORD_0 dst_unused:UNUSED_PRESERVE src0_sel:DWORD src1_sel:DWORD
    ds_add_rtn_u32 v187, v183, v29
    v_add_u32_sdwa v179, v247, s40 dst_sel:WORD_0 dst_unused:UNUSED_PRESERVE src0_sel:DWORD src1_sel:DWORD
    s_waitcnt lgkmcnt(0)
    v_min_u32 v184, 47, v184
    v_lshl_add_u32 v180, v184, 2, v180
    ds_write_b32 v180, v176 offset:4
    v_min_u32 v185, 47, v185
    v_lshl_add_u32 v181, v185, 2, v181
    ds_write_b32 v181, v177 offset:4
    v_min_u32 v186, 47, v186
    v_lshl_add_u32 v182, v186, 2, v182
    ds_write_b32 v182, v178 offset:4
    v_min_u32 v187, 47, v187
    v_lshl_add_u32 v183, v187, 2, v183
    ds_write_b32 v183, v179 offset:4
    v_cmp_lt_i32 vcc, 0, v33
    s_cbranch_vccz K_MORE_RET
K_MORE_F:
    ds_write_b32 v24, v29 offset:44032
    s_branch K_MORE_RET
K_SLOW0:
    ds_read_b64_tr_b16 a[184:185], v62 offset:0
    ds_read_b64_tr_b16 a[186:187], v62 offset:1024
    ds_read_b64_tr_b16 a[188:189], v62 offset:32
    ds_read_b64_tr_b16 a[190:191], v62 offset:1056
    ds_read_b64_tr_b16 a[192:193], v62 offset:2048
    ds_read_b64_tr_b16 a[194:195], v62 offset:3072
    ds_read_b64_tr_b16 a[196:197], v62 offset:2080
    ds_read_b64_tr_b16 a[198:199], v62 offset:3104
    ds_read_b64_tr_b16 a[200:201], v62 offset:4096
    ds_read_b64_tr_b16 a[202:203], v62 offset:5120
    ds_read_b64_tr_b16 a[204:205], v62 offset:4128
    ds_read_b64_tr_b16 a[206:207], v62 offset:5152
    ds_read_b64_tr_b16 a[208:209], v62 offset:6144
    ds_read_b64_tr_b16 a[210:211], v62 offset:7168
    ds_read_b64_tr_b16 a[212:213], v62 offset:6176
    ds_read_b64_tr_b16 a[214:215], v62 offset:7200
    ds_read_b64_tr_b16 a[216:217], v62 offset:8192
    ds_read_b64_tr_b16 a[218:219], v62 offset:9216
    ds_read_b64_tr_b16 a[220:221], v62 offset:8224
    ds_read_b64_tr_b16 a[222:223], v62 offset:9248
    ds_read_b64_tr_b16 a[224:225], v62 offset:10240
    ds_read_b64_tr_b16 a[226:227], v62 offset:11264
    ds_read_b64_tr_b16 a[228:229], v62 offset:10272
    ds_read_b64_tr_b16 a[230:231], v62 offset:11296
    ds_read_b64_tr_b16 a[232:233], v62 offset:12288
    ds_read_b64_tr_b16 a[234:235], v62 offset:13312
    ds_read_b64_tr_b16 a[236:237], v62 offset:12320
    ds_read_b64_tr_b16 a[238:239], v62 offset:13344
    ds_read_b64_tr_b16 a[240:241], v62 offset:14336
    ds_read_b64_tr_b16 a[242:243], v62 offset:15360
    ds_read_b64_tr_b16 a[244:245], v62 offset:14368
    ds_read_b64_tr_b16 a[246:247], v62 offset:15392
K_SLOW:
    s_mov_b64 exec, -1
    s_waitcnt vmcnt(0) lgkmcnt(0)
    s_barrier
    v_mbcnt_lo_u32_b32 v6, -1, 0
    v_mbcnt_hi_u32_b32 v6, -1, v6
    s_lshl_b32 s3, s18, 6
    v_add_u32 v7, s3, v6
    s_lshr_b32 s36, s84, 4
    s_lshl_b32 s36, s36, 14
    s_and_b32 s3, s84, 15
    s_lshl2_add_u32 s36, s3, s36
    v_lshlrev_b32 v3, 6, v7
    buffer_load_dword v8, v3, s[12:15], s36 offen sc1
    v_lshrrev_b32 v1, 5, v6
    v_lshlrev_b32 v1, 6, v1
    v_and_b32 v6, 31, v6
    v_lshlrev_b32 v2, 4, v7
    v_mov_b32 v16, 0
    v_mov_b32 v17, 0
    v_mov_b32 v18, 0
    v_mov_b32 v19, 0
    ds_write_b128 v2, v[16:19] offset:0
    ds_write_b128 v2, v[16:19] offset:4096
    ds_write_b128 v2, v[16:19] offset:8192
    ds_write_b128 v2, v[16:19] offset:12288
    ds_write_b128 v2, v[16:19] offset:16384
    ds_write_b128 v2, v[16:19] offset:20480
    ds_write_b128 v2, v[16:19] offset:24576
    ds_write_b128 v2, v[16:19] offset:28672
    ds_write_b128 v2, v[16:19] offset:32768
    ds_write_b128 v2, v[16:19] offset:36864
    ds_write_b128 v2, v[16:19] offset:40960
    ds_write_b128 v2, v[16:19] offset:45056
    ds_write_b128 v2, v[16:19] offset:49152
    s_movk_i32 s53, 0x3f80
    v_mov_b32 v48, s53
    v_mov_b32 v49, 0
    v_mov_b32 v50, 1.0
    v_mov_b32 v51, 0
    v_mov_b32 v15, 0x3f803f80
    s_mov_b32 s6, s26
    s_mov_b32 s19, 0
    s_waitcnt vmcnt(0) lgkmcnt(0)
    s_barrier
K_S_SEG:
    v_readlane_b32 s36, v8, s19
    s_lshl_b32 s3, s18, 6
    s_add_u32 s3, s3, s19
    s_mul_i32 s3, s3, 3200
    s_nop 0
    s_lshr_b32 s20, s36, 16
    s_and_b32 s36, s36, 0xffff
    s_add_u32 s36, s36, s3
K_S_TILE:
    s_cmp_le_i32 s20, 0
    s_cbranch_scc1 K_S_NEXT
    v_add_lshl_u32 v2, s36, v6, 2
    v_lshlrev_b32 v3, 1, v2
    v_cmp_gt_i32 s[38:39], s20, v6
    buffer_load_dword v9, v2, s[12:15], s50 offen sc1
    buffer_load_dwordx2 a[248:249], v3, s[12:15], s51 offen sc1
    s_waitcnt vmcnt(0)
    s_mov_b32 exec_lo, 0
    v_accvgpr_write_b32 a248, v15
    v_accvgpr_write_b32 a249, 0
    s_mov_b32 exec_lo, -1
    v_mad_u32_u16 v0, v9, s59, v1 op_sel:[1,0,0,0]
    buffer_load_dwordx4 a[0:3], v0, s[4:7], 0 offen offset:0
    buffer_load_dwordx4 a[4:7], v0, s[4:7], 0 offen offset:16
    buffer_load_dwordx4 a[8:11], v0, s[4:7], 0 offen offset:32
    buffer_load_dwordx4 a[12:15], v0, s[4:7], 0 offen offset:48
    v_and_b32 v9, 0xffff, v9
    v_lshl_add_u32 v0, v9, 7, v1
    v_subrev_u32 v9, s16, v9
    buffer_load_dwordx4 a[32:35], v0, s[4:7], 0 offen offset:0
    buffer_load_dwordx4 a[36:39], v0, s[4:7], 0 offen offset:16
    buffer_load_dwordx4 a[40:43], v0, s[4:7], 0 offen offset:32
    buffer_load_dwordx4 a[44:47], v0, s[4:7], 0 offen offset:48
    v_mul_u32_u24 v9, 260, v9
    v_lshl_add_u32 v9, v1, 1, v9
    s_waitcnt vmcnt(0)
    v_mfma_f32_32x32x16_bf16 v[64:79], a[112:115], a[32:35], 0
    v_mfma_f32_32x32x16_bf16 v[64:79], a[116:119], a[36:39], v[64:79]
    v_mfma_f32_32x32x16_bf16 v[64:79], a[120:123], a[40:43], v[64:79]
    v_mfma_f32_32x32x16_bf16 v[64:79], a[124:127], a[44:47], v[64:79]
    v_mfma_f32_32x32x16_bf16 v[64:79], a[48:51], a[0:3], v[64:79]
    v_mfma_f32_32x32x16_bf16 v[64:79], a[52:55], a[4:7], v[64:79]
    v_mfma_f32_32x32x16_bf16 v[64:79], a[56:59], a[8:11], v[64:79]
    v_mfma_f32_32x32x16_bf16 v[64:79], a[60:63], a[12:15], v[64:79]
    v_mfma_f32_32x32x8_bf16 v[64:79], a[176:177], a[248:249], v[64:79]
    v_mfma_f32_32x32x16_bf16 v[80:95], a[128:131], a[32:35], 0
    v_mfma_f32_32x32x16_bf16 v[80:95], a[132:135], a[36:39], v[80:95]
    v_mfma_f32_32x32x16_bf16 v[80:95], a[136:139], a[40:43], v[80:95]
    v_mfma_f32_32x32x16_bf16 v[80:95], a[140:143], a[44:47], v[80:95]
    v_mfma_f32_32x32x16_bf16 v[80:95], a[64:67], a[0:3], v[80:95]
    v_mfma_f32_32x32x16_bf16 v[80:95], a[68:71], a[4:7], v[80:95]
    v_mfma_f32_32x32x16_bf16 v[80:95], a[72:75], a[8:11], v[80:95]
    v_mfma_f32_32x32x16_bf16 v[80:95], a[76:79], a[12:15], v[80:95]
    v_mfma_f32_32x32x8_bf16 v[80:95], a[178:179], a[248:249], v[80:95]
    v_mfma_f32_32x32x16_bf16 v[96:111], a[144:147], a[32:35], 0
    v_mfma_f32_32x32x16_bf16 v[96:111], a[148:151], a[36:39], v[96:111]
    v_mfma_f32_32x32x16_bf16 v[96:111], a[152:155], a[40:43], v[96:111]
    v_mfma_f32_32x32x16_bf16 v[96:111], a[156:159], a[44:47], v[96:111]
    v_mfma_f32_32x32x16_bf16 v[96:111], a[80:83], a[0:3], v[96:111]
    v_mfma_f32_32x32x16_bf16 v[96:111], a[84:87], a[4:7], v[96:111]
    v_mfma_f32_32x32x16_bf16 v[96:111], a[88:91], a[8:11], v[96:111]
    v_mfma_f32_32x32x16_bf16 v[96:111], a[92:95], a[12:15], v[96:111]
    v_mfma_f32_32x32x8_bf16 v[96:111], a[180:181], a[248:249], v[96:111]
    v_mfma_f32_32x32x16_bf16 v[112:127], a[160:163], a[32:35], 0
    v_mfma_f32_32x32x16_bf16 v[112:127], a[164:167], a[36:39], v[112:127]
    v_mfma_f32_32x32x16_bf16 v[112:127], a[168:171], a[40:43], v[112:127]
    v_mfma_f32_32x32x16_bf16 v[112:127], a[172:175], a[44:47], v[112:127]
    v_mfma_f32_32x32x16_bf16 v[112:127], a[96:99], a[0:3], v[112:127]
    v_mfma_f32_32x32x16_bf16 v[112:127], a[100:103], a[4:7], v[112:127]
    v_mfma_f32_32x32x16_bf16 v[112:127], a[104:107], a[8:11], v[112:127]
    v_mfma_f32_32x32x16_bf16 v[112:127], a[108:111], a[12:15], v[112:127]
    v_mfma_f32_32x32x8_bf16 v[112:127], a[182:183], a[248:249], v[112:127]
    v_mfma_f32_32x32x8_bf16 v[16:31], a[254:255], v[48:49], 0
    v_mfma_f32_32x32x8_bf16 v[32:47], a[254:255], v[50:51], 0
    s_nop 15
    v_exp_f32 v128, v64
    v_exp_f32 v129, v65
    v_exp_f32 v130, v66
    v_exp_f32 v131, v67
    v_exp_f32 v132, v68
    v_exp_f32 v133, v69
    v_exp_f32 v134, v70
    v_exp_f32 v135, v71
    v_exp_f32 v136, v72
    v_exp_f32 v137, v73
    v_exp_f32 v138, v74
    v_exp_f32 v139, v75
    v_exp_f32 v140, v76
    v_exp_f32 v141, v77
    v_exp_f32 v142, v78
    v_exp_f32 v143, v79
    v_exp_f32 v144, v80
    v_exp_f32 v145, v81
    v_exp_f32 v146, v82
    v_exp_f32 v147, v83
    v_exp_f32 v148, v84
    v_exp_f32 v149, v85
    v_exp_f32 v150, v86
    v_exp_f32 v151, v87
    v_exp_f32 v152, v88
    v_exp_f32 v153, v89
    v_exp_f32 v154, v90
    v_exp_f32 v155, v91
    v_exp_f32 v156, v92
    v_exp_f32 v157, v93
    v_exp_f32 v158, v94
    v_exp_f32 v159, v95
    v_exp_f32 v160, v96
    v_exp_f32 v161, v97
    v_exp_f32 v162, v98
    v_exp_f32 v163, v99
    v_exp_f32 v164, v100
    v_exp_f32 v165, v101
    v_exp_f32 v166, v102
    v_exp_f32 v167, v103
    v_exp_f32 v168, v104
    v_exp_f32 v169, v105
    v_exp_f32 v170, v106
    v_exp_f32 v171, v107
    v_exp_f32 v172, v108
    v_exp_f32 v173, v109
    v_exp_f32 v174, v110
    v_exp_f32 v175, v111
    v_exp_f32 v176, v112
    v_exp_f32 v177, v113
    v_exp_f32 v178, v114
    v_exp_f32 v179, v115
    v_exp_f32 v180, v116
    v_exp_f32 v181, v117
    v_exp_f32 v182, v118
    v_exp_f32 v183, v119
    v_exp_f32 v184, v120
    v_exp_f32 v185, v121
    v_exp_f32 v186, v122
    v_exp_f32 v187, v123
    v_exp_f32 v188, v124
    v_exp_f32 v189, v125
    v_exp_f32 v190, v126
    v_exp_f32 v191, v127
    v_pk_add_f32 v[128:129], v[128:129], 1.0 op_sel_hi:[1,0]
    v_pk_add_f32 v[130:131], v[130:131], 1.0 op_sel_hi:[1,0]
    v_pk_add_f32 v[132:133], v[132:133], 1.0 op_sel_hi:[1,0]
    v_pk_add_f32 v[134:135], v[134:135], 1.0 op_sel_hi:[1,0]
    v_pk_add_f32 v[136:137], v[136:137], 1.0 op_sel_hi:[1,0]
    v_pk_add_f32 v[138:139], v[138:139], 1.0 op_sel_hi:[1,0]
    v_pk_add_f32 v[140:141], v[140:141], 1.0 op_sel_hi:[1,0]
    v_pk_add_f32 v[142:143], v[142:143], 1.0 op_sel_hi:[1,0]
    v_pk_add_f32 v[144:145], v[144:145], 1.0 op_sel_hi:[1,0]
    v_pk_add_f32 v[146:147], v[146:147], 1.0 op_sel_hi:[1,0]
    v_pk_add_f32 v[148:149], v[148:149], 1.0 op_sel_hi:[1,0]
    v_pk_add_f32 v[150:151], v[150:151], 1.0 op_sel_hi:[1,0]
    v_pk_add_f32 v[152:153], v[152:153], 1.0 op_sel_hi:[1,0]
    v_pk_add_f32 v[154:155], v[154:155], 1.0 op_sel_hi:[1,0]
    v_pk_add_f32 v[156:157], v[156:157], 1.0 op_sel_hi:[1,0]
    v_pk_add_f32 v[158:159], v[158:159], 1.0 op_sel_hi:[1,0]
    v_pk_add_f32 v[160:161], v[160:161], 1.0 op_sel_hi:[1,0]
    v_pk_add_f32 v[162:163], v[162:163], 1.0 op_sel_hi:[1,0]
    v_pk_add_f32 v[164:165], v[164:165], 1.0 op_sel_hi:[1,0]
    v_pk_add_f32 v[166:167], v[166:167], 1.0 op_sel_hi:[1,0]
    v_pk_add_f32 v[168:169], v[168:169], 1.0 op_sel_hi:[1,0]
    v_pk_add_f32 v[170:171], v[170:171], 1.0 op_sel_hi:[1,0]
    v_pk_add_f32 v[172:173], v[172:173], 1.0 op_sel_hi:[1,0]
    v_pk_add_f32 v[174:175], v[174:175], 1.0 op_sel_hi:[1,0]
    v_pk_add_f32 v[176:177], v[176:177], 1.0 op_sel_hi:[1,0]
    v_pk_add_f32 v[178:179], v[178:179], 1.0 op_sel_hi:[1,0]
    v_pk_add_f32 v[180:181], v[180:181], 1.0 op_sel_hi:[1,0]
    v_pk_add_f32 v[182:183], v[182:183], 1.0 op_sel_hi:[1,0]
    v_pk_add_f32 v[184:185], v[184:185], 1.0 op_sel_hi:[1,0]
    v_pk_add_f32 v[186:187], v[186:187], 1.0 op_sel_hi:[1,0]
    v_pk_add_f32 v[188:189], v[188:189], 1.0 op_sel_hi:[1,0]
    v_pk_add_f32 v[190:191], v[190:191], 1.0 op_sel_hi:[1,0]
    v_rcp_f32 v128, v128
    v_rcp_f32 v129, v129
    v_rcp_f32 v130, v130
    v_rcp_f32 v131, v131
    v_rcp_f32 v132, v132
    v_rcp_f32 v133, v133
    v_rcp_f32 v134, v134
    v_rcp_f32 v135, v135
    v_rcp_f32 v136, v136
    v_rcp_f32 v137, v137
    v_rcp_f32 v138, v138
    v_rcp_f32 v139, v139
    v_rcp_f32 v140, v140
    v_rcp_f32 v141, v141
    v_rcp_f32 v142, v142
    v_rcp_f32 v143, v143
    v_rcp_f32 v144, v144
    v_rcp_f32 v145, v145
    v_rcp_f32 v146, v146
    v_rcp_f32 v147, v147
    v_rcp_f32 v148, v148
    v_rcp_f32 v149, v149
    v_rcp_f32 v150, v150
    v_rcp_f32 v151, v151
    v_rcp_f32 v152, v152
    v_rcp_f32 v153, v153
    v_rcp_f32 v154, v154
    v_rcp_f32 v155, v155
    v_rcp_f32 v156, v156
    v_rcp_f32 v157, v157
    v_rcp_f32 v158, v158
    v_rcp_f32 v159, v159
    v_rcp_f32 v160, v160
    v_rcp_f32 v161, v161
    v_rcp_f32 v162, v162
    v_rcp_f32 v163, v163
    v_rcp_f32 v164, v164
    v_rcp_f32 v165, v165
    v_rcp_f32 v166, v166
    v_rcp_f32 v167, v167
    v_rcp_f32 v168, v168
    v_rcp_f32 v169, v169
    v_rcp_f32 v170, v170
    v_rcp_f32 v171, v171
    v_rcp_f32 v172, v172
    v_rcp_f32 v173, v173
    v_rcp_f32 v174, v174
    v_rcp_f32 v175, v175
    v_rcp_f32 v176, v176
    v_rcp_f32 v177, v177
    v_rcp_f32 v178, v178
    v_rcp_f32 v179, v179
    v_rcp_f32 v180, v180
    v_rcp_f32 v181, v181
    v_rcp_f32 v182, v182
    v_rcp_f32 v183, v183
    v_rcp_f32 v184, v184
    v_rcp_f32 v185, v185
    v_rcp_f32 v186, v186
    v_rcp_f32 v187, v187
    v_rcp_f32 v188, v188
    v_rcp_f32 v189, v189
    v_rcp_f32 v190, v190
    v_rcp_f32 v191, v191
    v_pk_mul_f32 v[64:65], v[64:65], v[128:129]
    v_pk_mul_f32 v[66:67], v[66:67], v[130:131]
    v_pk_mul_f32 v[68:69], v[68:69], v[132:133]
    v_pk_mul_f32 v[70:71], v[70:71], v[134:135]
    v_pk_mul_f32 v[72:73], v[72:73], v[136:137]
    v_pk_mul_f32 v[74:75], v[74:75], v[138:139]
    v_pk_mul_f32 v[76:77], v[76:77], v[140:141]
    v_pk_mul_f32 v[78:79], v[78:79], v[142:143]
    v_cvt_pk_bf16_f32 v64, v64, v65
    v_cvt_pk_bf16_f32 v65, v66, v67
    v_cvt_pk_bf16_f32 v66, v68, v69
    v_cvt_pk_bf16_f32 v67, v70, v71
    v_cvt_pk_bf16_f32 v68, v72, v73
    v_cvt_pk_bf16_f32 v69, v74, v75
    v_cvt_pk_bf16_f32 v70, v76, v77
    v_cvt_pk_bf16_f32 v71, v78, v79
    v_pk_mul_f32 v[80:81], v[80:81], v[144:145]
    v_pk_mul_f32 v[82:83], v[82:83], v[146:147]
    v_pk_mul_f32 v[84:85], v[84:85], v[148:149]
    v_pk_mul_f32 v[86:87], v[86:87], v[150:151]
    v_pk_mul_f32 v[88:89], v[88:89], v[152:153]
    v_pk_mul_f32 v[90:91], v[90:91], v[154:155]
    v_pk_mul_f32 v[92:93], v[92:93], v[156:157]
    v_pk_mul_f32 v[94:95], v[94:95], v[158:159]
    v_cvt_pk_bf16_f32 v80, v80, v81
    v_cvt_pk_bf16_f32 v81, v82, v83
    v_cvt_pk_bf16_f32 v82, v84, v85
    v_cvt_pk_bf16_f32 v83, v86, v87
    v_cvt_pk_bf16_f32 v84, v88, v89
    v_cvt_pk_bf16_f32 v85, v90, v91
    v_cvt_pk_bf16_f32 v86, v92, v93
    v_cvt_pk_bf16_f32 v87, v94, v95
    v_pk_mul_f32 v[96:97], v[96:97], v[160:161]
    v_pk_mul_f32 v[98:99], v[98:99], v[162:163]
    v_pk_mul_f32 v[100:101], v[100:101], v[164:165]
    v_pk_mul_f32 v[102:103], v[102:103], v[166:167]
    v_pk_mul_f32 v[104:105], v[104:105], v[168:169]
    v_pk_mul_f32 v[106:107], v[106:107], v[170:171]
    v_pk_mul_f32 v[108:109], v[108:109], v[172:173]
    v_pk_mul_f32 v[110:111], v[110:111], v[174:175]
    v_cvt_pk_bf16_f32 v96, v96, v97
    v_cvt_pk_bf16_f32 v97, v98, v99
    v_cvt_pk_bf16_f32 v98, v100, v101
    v_cvt_pk_bf16_f32 v99, v102, v103
    v_cvt_pk_bf16_f32 v100, v104, v105
    v_cvt_pk_bf16_f32 v101, v106, v107
    v_cvt_pk_bf16_f32 v102, v108, v109
    v_cvt_pk_bf16_f32 v103, v110, v111
    v_pk_mul_f32 v[112:113], v[112:113], v[176:177]
    v_pk_mul_f32 v[114:115], v[114:115], v[178:179]
    v_pk_mul_f32 v[116:117], v[116:117], v[180:181]
    v_pk_mul_f32 v[118:119], v[118:119], v[182:183]
    v_pk_mul_f32 v[120:121], v[120:121], v[184:185]
    v_pk_mul_f32 v[122:123], v[122:123], v[186:187]
    v_pk_mul_f32 v[124:125], v[124:125], v[188:189]
    v_pk_mul_f32 v[126:127], v[126:127], v[190:191]
    v_cvt_pk_bf16_f32 v112, v112, v113
    v_cvt_pk_bf16_f32 v113, v114, v115
    v_cvt_pk_bf16_f32 v114, v116, v117
    v_cvt_pk_bf16_f32 v115, v118, v119
    v_cvt_pk_bf16_f32 v116, v120, v121
    v_cvt_pk_bf16_f32 v117, v122, v123
    v_cvt_pk_bf16_f32 v118, v124, v125
    v_cvt_pk_bf16_f32 v119, v126, v127
    s_nop 1
    v_mfma_f32_32x32x16_bf16 v[16:31], a[184:187], v[64:67], v[16:31]
    v_mfma_f32_32x32x16_bf16 v[32:47], a[188:191], v[64:67], v[32:47]
    v_mfma_f32_32x32x16_bf16 v[16:31], a[192:195], v[68:71], v[16:31]
    v_mfma_f32_32x32x16_bf16 v[32:47], a[196:199], v[68:71], v[32:47]
    v_mfma_f32_32x32x16_bf16 v[16:31], a[200:203], v[80:83], v[16:31]
    v_mfma_f32_32x32x16_bf16 v[32:47], a[204:207], v[80:83], v[32:47]
    v_mfma_f32_32x32x16_bf16 v[16:31], a[208:211], v[84:87], v[16:31]
    v_mfma_f32_32x32x16_bf16 v[32:47], a[212:215], v[84:87], v[32:47]
    v_mfma_f32_32x32x16_bf16 v[16:31], a[216:219], v[96:99], v[16:31]
    v_mfma_f32_32x32x16_bf16 v[32:47], a[220:223], v[96:99], v[32:47]
    v_mfma_f32_32x32x16_bf16 v[16:31], a[224:227], v[100:103], v[16:31]
    v_mfma_f32_32x32x16_bf16 v[32:47], a[228:231], v[100:103], v[32:47]
    v_mfma_f32_32x32x16_bf16 v[16:31], a[232:235], v[112:115], v[16:31]
    v_mfma_f32_32x32x16_bf16 v[32:47], a[236:239], v[112:115], v[32:47]
    v_mfma_f32_32x32x16_bf16 v[16:31], a[240:243], v[116:119], v[16:31]
    v_mfma_f32_32x32x16_bf16 v[32:47], a[244:247], v[116:119], v[32:47]
    s_nop 15
    s_mov_b64 exec, s[38:39]
    ds_add_f32 v9, v16 offset:0
    ds_add_f32 v9, v17 offset:4
    ds_add_f32 v9, v18 offset:8
    ds_add_f32 v9, v19 offset:12
    ds_add_f32 v9, v20 offset:16
    ds_add_f32 v9, v21 offset:20
    ds_add_f32 v9, v22 offset:24
    ds_add_f32 v9, v23 offset:28
    ds_add_f32 v9, v24 offset:32
    ds_add_f32 v9, v25 offset:36
    ds_add_f32 v9, v26 offset:40
    ds_add_f32 v9, v27 offset:44
    ds_add_f32 v9, v28 offset:48
    ds_add_f32 v9, v29 offset:52
    ds_add_f32 v9, v30 offset:56
    ds_add_f32 v9, v31 offset:60
    ds_add_f32 v9, v32 offset:64
    ds_add_f32 v9, v33 offset:68
    ds_add_f32 v9, v34 offset:72
    ds_add_f32 v9, v35 offset:76
    ds_add_f32 v9, v36 offset:80
    ds_add_f32 v9, v37 offset:84
    ds_add_f32 v9, v38 offset:88
    ds_add_f32 v9, v39 offset:92
    ds_add_f32 v9, v40 offset:96
    ds_add_f32 v9, v41 offset:100
    ds_add_f32 v9, v42 offset:104
    ds_add_f32 v9, v43 offset:108
    ds_add_f32 v9, v44 offset:112
    ds_add_f32 v9, v45 offset:116
    ds_add_f32 v9, v46 offset:120
    ds_add_f32 v9, v47 offset:124
    s_mov_b64 exec, -1
    s_waitcnt lgkmcnt(0)
    s_sub_u32 s20, s20, 32
    s_add_u32 s36, s36, 32
    s_branch K_S_TILE
K_S_NEXT:
    s_add_u32 s19, s19, 1
    s_cmp_lt_u32 s19, 64
    s_cbranch_scc1 K_S_SEG
    s_barrier
    v_and_b32 v3, 7, v7
    v_lshlrev_b32 v1, 4, v3
    v_lshrrev_b32 v7, 3, v7
    s_mov_b32 s19, 0
K_S_OUT:
    v_mul_u32_u24 v2, 260, v7
    v_cmp_gt_u32 vcc, s17, v7
    v_lshl_add_u32 v2, v3, 5, v2
    v_add_lshl_u32 v0, s16, v7, 7
    v_cndmask_b32 v0, 2.0, v0, vcc
    v_or_b32 v0, v0, v1
    ds_read_b32 v16, v2 offset:0
    ds_read_b32 v17, v2 offset:4
    ds_read_b32 v18, v2 offset:8
    ds_read_b32 v19, v2 offset:12
    ds_read_b32 v20, v2 offset:16
    ds_read_b32 v21, v2 offset:20
    ds_read_b32 v22, v2 offset:24
    ds_read_b32 v23, v2 offset:28
    s_waitcnt lgkmcnt(0)
    v_cvt_pk_bf16_f32 v24, v16, v17
    v_cvt_pk_bf16_f32 v25, v18, v19
    v_cvt_pk_bf16_f32 v26, v20, v21
    v_cvt_pk_bf16_f32 v27, v22, v23
    buffer_store_dwordx4 v[24:27], v0, s[8:11], 0 offen
    v_add_u32 v7, 32, v7
    s_waitcnt vmcnt(0)
    s_add_u32 s19, s19, 1
    s_cmp_lt_u32 s19, 7
    s_cbranch_scc1 K_S_OUT
    s_endpgm
.section .rodata,"a"
.p2align 6
.amdhsa_kernel standalone__edge_featured_mpnn_mpnn__graph_kernel
  .amdhsa_next_free_vgpr 512
  .amdhsa_next_free_sgpr 102
  .amdhsa_accum_offset 256
  .amdhsa_group_segment_fixed_size 0
  .amdhsa_kernarg_size 88
  .amdhsa_user_sgpr_count 2
  .amdhsa_user_sgpr_kernarg_segment_ptr 1
  .amdhsa_system_sgpr_workgroup_id_x 1
  .amdhsa_float_denorm_mode_32 3
.end_amdhsa_kernel
```
